```python
import torch

def _softmax(x, axis=-1):
    return torch.softmax(x, dim=axis)
def _gelu(x):
    return torch.nn.functional.gelu(x, approximate="tanh")
def _silu(x):
    return torch.nn.functional.silu(x)
def _sigmoid(x):
    return torch.sigmoid(x)
def _layernorm(x, axis=-1, eps=1e-5):
    m = x.mean(dim=axis, keepdim=True)
    v = x.var(dim=axis, keepdim=True, unbiased=False)
    return (x - m) / torch.sqrt(v + eps)
def _scatter_add(tgt, idx, src, axis=0):
    return tgt.clone().index_add_(axis, idx, src)
def _segment_sum(src, seg, n):
    out = torch.zeros((n,) + src.shape[1:], dtype=src.dtype)
    return out.index_add_(0, seg, src)
def _pad(x, pw):
    flat = tuple(v for pair in reversed(pw) for v in pair)
    return torch.nn.functional.pad(x, flat)

kernel_name = 'parallel_sum__softmax_full_mha__glu_gated_bilinear__prompt'

def setup_inputs():

    _w = (lambda a: (lambda t: t.to(torch.bfloat16) if t.is_floating_point() else t)(torch.as_tensor(a)))
    def _A_setup():
        B, S, D = 1, 2048, 512
        return {
            "x": _w((lambda *s: torch.randn(*s, dtype=torch.bfloat16) * 0.05)(B, S, D)),
            "wqkv": _w((lambda *s: torch.randn(*s, dtype=torch.bfloat16) * 0.05)(D, 3 * D)),
            "wo": _w((lambda *s: torch.randn(*s, dtype=torch.bfloat16) * 0.05)(D, D)),
        }
    _A_in = _A_setup()

    def _B_setup():
        B, S, D, F = 1, 2048, 512, 1792
        return {
            "x": _w((lambda *s: torch.randn(*s, dtype=torch.bfloat16) * 0.05)(B, S, D)),
            "w_gate": _w((lambda *s: torch.randn(*s, dtype=torch.bfloat16) * 0.4)(D, F) * (D ** -0.5)),
            "w_up": _w((lambda *s: torch.randn(*s, dtype=torch.bfloat16) * 0.4)(D, F) * (D ** -0.5)),
            "w_down": _w((lambda *s: torch.randn(*s, dtype=torch.bfloat16) * 0.4)(F, D) * (F ** -0.5)),
        }
    _B_in = _B_setup()

    return {
        "A_x": _A_in["x"],
        "A_wqkv": _A_in["wqkv"],
        "A_wo": _A_in["wo"],
        "B_x": _B_in["x"],
        "B_w_gate": _B_in["w_gate"],
        "B_w_up": _B_in["w_up"],
        "B_w_down": _B_in["w_down"],
    }

def reference(A_x, A_wqkv, A_wo, B_x, B_w_gate, B_w_up, B_w_down):
    def _A_ref(x, wqkv, wo):
        B, S, D = x.shape
        H = 32; Dh = D // H
        qkv = (lambda x, *d: x.permute(*d))((x @ wqkv).reshape(B, S, 3, H, Dh), 2, 0, 3, 1, 4)
        q, k, v = qkv[0], qkv[1], qkv[2]
        scale = Dh ** -0.5
        scores = torch.einsum("bhqd,bhkd->bhqk", q, k) * scale
        p = _softmax(scores, axis=-1)
        o = torch.einsum("bhqk,bhkd->bhqd", p, v)
        return (lambda x, *d: x.permute(*d))(o, 0, 2, 1, 3).reshape(B, S, D) @ wo

    def _B_ref(x, w_gate, w_up, w_down):
        g = torch.einsum("bsd,df->bsf", x, w_gate)
        u = torch.einsum("bsd,df->bsf", x, w_up)
        h = g * u
        return torch.einsum("bsf,fd->bsd", h, w_down)

    x = A_x
    xn = _layernorm(x, axis=-1)
    return x + _A_ref(xn, A_wqkv, A_wo) + _B_ref(xn, B_w_gate, B_w_up, B_w_down)
```

```asm
; @launch grid=(256,1,1) block=(512,1,1) lds=163840
    .amdgcn_target "amdgcn-amd-amdhsa--gfx950"
    .text
    .globl parallel_sum__softmax_full_mha__glu_gated_bilinear__prompt_kernel
    .p2align 8
    .type parallel_sum__softmax_full_mha__glu_gated_bilinear__prompt_kernel,@function
parallel_sum__softmax_full_mha__glu_gated_bilinear__prompt_kernel:
    s_cmp_ge_u32 s2, 256
    s_cbranch_scc1 L_k1_exit
    s_load_dwordx4 s[4:7], s[0:1], 0
    s_load_dwordx2 s[8:9], s[0:1], 16
    s_load_dwordx2 s[10:11], s[0:1], 48
    s_load_dwordx4 s[12:15], s[0:1], 32
    s_load_dwordx2 s[16:17], s[0:1], 72
    v_readfirstlane_b32 s40, v0
    v_and_b32 v1, 63, v0
    s_and_b32 s53, s2, 1
    s_lshl_b32 s53, s53, 3
    s_bfe_u32 s54, s2, 0x30003
    s_add_u32 s42, s53, s54
    s_lshr_b32 s40, s40, 6
    s_cmp_ge_u32 s40, 4
    s_cbranch_scc1 L_k1_loader
    v_lshlrev_b32 v26, 4, v1
    s_lshl_b32 s67, s2, 13
    s_lshl_b32 s53, s40, 11
    s_add_u32 s67, s67, s53
    s_waitcnt lgkmcnt(0)
    s_mov_b32 s68, s4
    s_and_b32 s69, s5, 0xffff
    s_mov_b32 s70, 0x200000
    s_mov_b32 s71, 0x20000
    buffer_load_dwordx4 v[6:9], v26, s[68:71], s67 offen
    buffer_load_dwordx4 v[6:9], v26, s[68:71], s67 offen offset:1024
    s_lshl_b32 s41, s42, 2
    s_add_u32 s41, s41, s40
    s_bfe_u32 s53, s2, 0x20001
    s_lshr_b32 s54, s2, 6
    s_mul_i32 s55, s53, 3
    s_add_u32 s55, s55, s54
    s_add_u32 s43, s55, 11
    s_mul_i32 s55, s53, 3
    s_add_u32 s55, s55, s43
    s_sub_u32 s55, s55, 12
    s_mul_i32 s44, s55, 0x01010100
    s_add_u32 s44, s44, s43
    s_add_u32 s44, s44, 0x23402000
    s_add_u32 s45, s55, 0x806043
    s_cmp_lg_u32 s54, 0
    s_cbranch_scc1 L_kindA_1
    s_mul_i32 s54, s53, 0x01010202
    s_add_u32 s44, s54, 0x38080100
    s_add_u32 s45, s53, 0x806058
L_kindA_1:
    v_lshrrev_b32 v16, 5, v1
    v_bfe_u32 v17, v1, 3, 2
    v_lshlrev_b32 v20, 13, v17
    v_and_b32 v17, 7, v1
    v_lshl_add_u32 v20, v17, 7, v20
    v_bfe_u32 v17, v1, 1, 3
    v_xor_b32 v17, v16, v17
    v_lshl_add_u32 v20, v17, 4, v20
    s_add_u32 s53, s40, 1
    s_lshl_b32 s53, s53, 15
    v_add_u32 v20, s53, v20
    v_xor_b32 v21, 32, v20
    v_xor_b32 v22, 64, v20
    v_xor_b32 v23, 0x60, v20
    v_lshrrev_b32 v16, 4, v1
    v_bfe_u32 v17, v1, 2, 2
    v_xor_b32 v24, v16, v17
    v_and_b32 v24, 1, v24
    v_cmp_eq_u32 vcc, 0, v24
    v_mov_b32 v24, 0x3f803f80
    v_mov_b32 v44, 0
    v_cndmask_b32 v40, 0, v24, vcc
    v_cmp_eq_u32 vcc, v16, v17
    v_and_b32 v24, 1, v1
    v_lshlrev_b32 v24, 4, v24
    v_mov_b32 v25, 0x3f80
    v_lshlrev_b32 v25, v24, v25
    v_cndmask_b32 v25, 0, v25, vcc
    v_bfe_u32 v24, v1, 1, 1
    v_cmp_eq_u32 vcc, 0, v24
    v_mov_b32 v34, 0
    v_mov_b32 v35, 0
    v_cndmask_b32 v36, 0, v25, vcc
    v_sub_u32 v37, v25, v36
    v_mov_b32 v38, 0
    v_mov_b32 v39, 0
    v_mov_b32 v45, 0
    v_mov_b32 v46, 0
    v_mov_b32 v47, 0
    v_mov_b32 v48, 0
    v_mov_b32 v49, 0
    v_mov_b32 v41, v40
    v_mov_b32 v42, v40
    v_mov_b32 v43, v40
    v_lshrrev_b32 v16, 5, v1
    v_lshlrev_b32 v4, 10, v16
    v_bfe_u32 v16, v1, 2, 2
    v_lshl_add_u32 v4, v16, 7, v4
    v_lshrrev_b32 v16, 1, v16
    v_lshl_add_u32 v4, v16, 6, v4
    v_bfe_u32 v16, v1, 4, 1
    v_lshl_add_u32 v4, v16, 5, v4
    v_and_b32 v16, 3, v1
    v_lshl_add_u32 v4, v16, 3, v4
    v_xor_b32 v5, 64, v4
    v_lshlrev_b32 v10, 4, v1
    v_lshrrev_b32 v16, 5, v1
    v_lshlrev_b32 v11, 8, v16
    v_bfe_u32 v16, v1, 4, 1
    v_lshl_add_u32 v11, v16, 16, v11
    v_and_b32 v17, 15, v1
    v_lshl_add_u32 v11, v17, 4, v11
    s_waitcnt lgkmcnt(0)
    s_mov_b32 s28, s16
    s_and_b32 s29, s17, 0xffff
    s_mov_b32 s30, 0x2000000
    s_mov_b32 s31, 0x20000
    s_cmp_eq_u32 s40, 1
    s_cselect_b32 s68, s12, s6
    s_cselect_b32 s69, s13, s7
    s_cmp_eq_u32 s40, 2
    s_cselect_b32 s68, s14, s68
    s_cselect_b32 s69, s15, s69
    s_cmp_eq_u32 s40, 3
    s_cselect_b32 s68, s10, s68
    s_cselect_b32 s69, s11, s69
    s_and_b32 s69, s69, 0xffff
    s_mov_b32 s70, 0x1c0000
    s_mov_b32 s71, 0x20000
    s_movk_i32 s53, 7168
    s_cmp_eq_u32 s40, 0
    s_cselect_b32 s70, 0x180000, s70
    s_cselect_b32 s53, 6144, s53
    s_mul_i32 s53, s53, s2
    s_mov_b32 s67, s53
    s_mov_b32 s68, s6
    s_and_b32 s69, s7, 0xffff
    s_mov_b32 s70, 0x180000
    s_mul_i32 s67, s2, 6144
    s_mul_i32 s53, s40, 1536
    s_add_u32 s67, s67, s53
    s_barrier
    ds_read_b128 v[128:131], v20 offset:0
    ds_read_b128 v[132:135], v21 offset:0
    ds_read_b128 v[136:139], v22 offset:0
    ds_read_b128 v[140:143], v23 offset:0
    ds_read_b128 v[144:147], v20 offset:1024
    ds_read_b128 v[148:151], v21 offset:1024
    ds_read_b128 v[152:155], v22 offset:1024
    ds_read_b128 v[156:159], v23 offset:1024
    s_waitcnt lgkmcnt(4)
    v_mfma_f32_16x16x32_bf16 v[44:47], v[40:43], v[128:131], v[44:47]
    v_dot2c_f32_bf16 v48, v128, v128
    v_dot2c_f32_bf16 v49, v129, v129
    v_dot2c_f32_bf16 v48, v130, v130
    v_dot2c_f32_bf16 v49, v131, v131
    v_mfma_f32_16x16x32_bf16 v[44:47], v[40:43], v[132:135], v[44:47]
    v_dot2c_f32_bf16 v48, v132, v132
    v_dot2c_f32_bf16 v49, v133, v133
    v_dot2c_f32_bf16 v48, v134, v134
    v_dot2c_f32_bf16 v49, v135, v135
    v_mfma_f32_16x16x32_bf16 v[44:47], v[40:43], v[136:139], v[44:47]
    v_dot2c_f32_bf16 v48, v136, v136
    v_dot2c_f32_bf16 v49, v137, v137
    v_dot2c_f32_bf16 v48, v138, v138
    v_dot2c_f32_bf16 v49, v139, v139
    v_mfma_f32_16x16x32_bf16 v[44:47], v[40:43], v[140:143], v[44:47]
    v_dot2c_f32_bf16 v48, v140, v140
    v_dot2c_f32_bf16 v49, v141, v141
    v_dot2c_f32_bf16 v48, v142, v142
    v_dot2c_f32_bf16 v49, v143, v143
    s_waitcnt lgkmcnt(0)
    v_mfma_f32_16x16x32_bf16 v[44:47], v[40:43], v[144:147], v[44:47]
    v_dot2c_f32_bf16 v48, v144, v144
    v_dot2c_f32_bf16 v49, v145, v145
    v_dot2c_f32_bf16 v48, v146, v146
    v_dot2c_f32_bf16 v49, v147, v147
    v_mfma_f32_16x16x32_bf16 v[44:47], v[40:43], v[148:151], v[44:47]
    v_dot2c_f32_bf16 v48, v148, v148
    v_dot2c_f32_bf16 v49, v149, v149
    v_dot2c_f32_bf16 v48, v150, v150
    v_dot2c_f32_bf16 v49, v151, v151
    v_mfma_f32_16x16x32_bf16 v[44:47], v[40:43], v[152:155], v[44:47]
    v_dot2c_f32_bf16 v48, v152, v152
    v_dot2c_f32_bf16 v49, v153, v153
    v_dot2c_f32_bf16 v48, v154, v154
    v_dot2c_f32_bf16 v49, v155, v155
    v_mfma_f32_16x16x32_bf16 v[44:47], v[40:43], v[156:159], v[44:47]
    v_dot2c_f32_bf16 v48, v156, v156
    v_dot2c_f32_bf16 v49, v157, v157
    v_dot2c_f32_bf16 v48, v158, v158
    v_dot2c_f32_bf16 v49, v159, v159
    s_barrier
    ds_read_b128 v[160:163], v20 offset:2048
    ds_read_b128 v[164:167], v21 offset:2048
    ds_read_b128 v[168:171], v22 offset:2048
    ds_read_b128 v[172:175], v23 offset:2048
    ds_read_b128 v[176:179], v20 offset:3072
    ds_read_b128 v[180:183], v21 offset:3072
    ds_read_b128 v[184:187], v22 offset:3072
    ds_read_b128 v[188:191], v23 offset:3072
    s_waitcnt lgkmcnt(4)
    v_mfma_f32_16x16x32_bf16 v[44:47], v[40:43], v[160:163], v[44:47]
    v_dot2c_f32_bf16 v48, v160, v160
    v_dot2c_f32_bf16 v49, v161, v161
    v_dot2c_f32_bf16 v48, v162, v162
    v_dot2c_f32_bf16 v49, v163, v163
    v_mfma_f32_16x16x32_bf16 v[44:47], v[40:43], v[164:167], v[44:47]
    v_dot2c_f32_bf16 v48, v164, v164
    v_dot2c_f32_bf16 v49, v165, v165
    v_dot2c_f32_bf16 v48, v166, v166
    v_dot2c_f32_bf16 v49, v167, v167
    v_mfma_f32_16x16x32_bf16 v[44:47], v[40:43], v[168:171], v[44:47]
    v_dot2c_f32_bf16 v48, v168, v168
    v_dot2c_f32_bf16 v49, v169, v169
    v_dot2c_f32_bf16 v48, v170, v170
    v_dot2c_f32_bf16 v49, v171, v171
    v_mfma_f32_16x16x32_bf16 v[44:47], v[40:43], v[172:175], v[44:47]
    v_dot2c_f32_bf16 v48, v172, v172
    v_dot2c_f32_bf16 v49, v173, v173
    v_dot2c_f32_bf16 v48, v174, v174
    v_dot2c_f32_bf16 v49, v175, v175
    s_waitcnt lgkmcnt(0)
    v_mfma_f32_16x16x32_bf16 v[44:47], v[40:43], v[176:179], v[44:47]
    v_dot2c_f32_bf16 v48, v176, v176
    v_dot2c_f32_bf16 v49, v177, v177
    v_dot2c_f32_bf16 v48, v178, v178
    v_dot2c_f32_bf16 v49, v179, v179
    v_mfma_f32_16x16x32_bf16 v[44:47], v[40:43], v[180:183], v[44:47]
    v_dot2c_f32_bf16 v48, v180, v180
    v_dot2c_f32_bf16 v49, v181, v181
    v_dot2c_f32_bf16 v48, v182, v182
    v_dot2c_f32_bf16 v49, v183, v183
    v_mfma_f32_16x16x32_bf16 v[44:47], v[40:43], v[184:187], v[44:47]
    v_dot2c_f32_bf16 v48, v184, v184
    v_dot2c_f32_bf16 v49, v185, v185
    v_dot2c_f32_bf16 v48, v186, v186
    v_dot2c_f32_bf16 v49, v187, v187
    v_mfma_f32_16x16x32_bf16 v[44:47], v[40:43], v[188:191], v[44:47]
    v_dot2c_f32_bf16 v48, v188, v188
    v_dot2c_f32_bf16 v49, v189, v189
    v_dot2c_f32_bf16 v48, v190, v190
    v_dot2c_f32_bf16 v49, v191, v191
    s_barrier
    buffer_load_dwordx4 v[6:9], v10, s[68:71], s67 offen offset:0
    buffer_load_dwordx4 v[6:9], v10, s[68:71], s67 offen offset:1024
    ds_read_b128 v[192:195], v20 offset:4096
    ds_read_b128 v[196:199], v21 offset:4096
    ds_read_b128 v[200:203], v22 offset:4096
    ds_read_b128 v[204:207], v23 offset:4096
    ds_read_b128 v[208:211], v20 offset:5120
    ds_read_b128 v[212:215], v21 offset:5120
    ds_read_b128 v[216:219], v22 offset:5120
    ds_read_b128 v[220:223], v23 offset:5120
    s_waitcnt lgkmcnt(4)
    v_mfma_f32_16x16x32_bf16 v[44:47], v[40:43], v[192:195], v[44:47]
    v_dot2c_f32_bf16 v48, v192, v192
    v_dot2c_f32_bf16 v49, v193, v193
    v_dot2c_f32_bf16 v48, v194, v194
    v_dot2c_f32_bf16 v49, v195, v195
    v_mfma_f32_16x16x32_bf16 v[44:47], v[40:43], v[196:199], v[44:47]
    v_dot2c_f32_bf16 v48, v196, v196
    v_dot2c_f32_bf16 v49, v197, v197
    v_dot2c_f32_bf16 v48, v198, v198
    v_dot2c_f32_bf16 v49, v199, v199
    v_mfma_f32_16x16x32_bf16 v[44:47], v[40:43], v[200:203], v[44:47]
    v_dot2c_f32_bf16 v48, v200, v200
    v_dot2c_f32_bf16 v49, v201, v201
    v_dot2c_f32_bf16 v48, v202, v202
    v_dot2c_f32_bf16 v49, v203, v203
    v_mfma_f32_16x16x32_bf16 v[44:47], v[40:43], v[204:207], v[44:47]
    v_dot2c_f32_bf16 v48, v204, v204
    v_dot2c_f32_bf16 v49, v205, v205
    v_dot2c_f32_bf16 v48, v206, v206
    v_dot2c_f32_bf16 v49, v207, v207
    s_waitcnt lgkmcnt(0)
    v_mfma_f32_16x16x32_bf16 v[44:47], v[40:43], v[208:211], v[44:47]
    v_dot2c_f32_bf16 v48, v208, v208
    v_dot2c_f32_bf16 v49, v209, v209
    v_dot2c_f32_bf16 v48, v210, v210
    v_dot2c_f32_bf16 v49, v211, v211
    v_mfma_f32_16x16x32_bf16 v[44:47], v[40:43], v[212:215], v[44:47]
    v_dot2c_f32_bf16 v48, v212, v212
    v_dot2c_f32_bf16 v49, v213, v213
    v_dot2c_f32_bf16 v48, v214, v214
    v_dot2c_f32_bf16 v49, v215, v215
    v_mfma_f32_16x16x32_bf16 v[44:47], v[40:43], v[216:219], v[44:47]
    v_dot2c_f32_bf16 v48, v216, v216
    v_dot2c_f32_bf16 v49, v217, v217
    v_dot2c_f32_bf16 v48, v218, v218
    v_dot2c_f32_bf16 v49, v219, v219
    v_mfma_f32_16x16x32_bf16 v[44:47], v[40:43], v[220:223], v[44:47]
    v_dot2c_f32_bf16 v48, v220, v220
    v_dot2c_f32_bf16 v49, v221, v221
    v_dot2c_f32_bf16 v48, v222, v222
    v_dot2c_f32_bf16 v49, v223, v223
    s_barrier
    s_getpc_b64 s[72:73]
L_pc_2:
    s_sub_u32 s72, s72, L_pc_2-parallel_sum__softmax_full_mha__glu_gated_bilinear__prompt_kernel
    s_subb_u32 s73, s73, 0
    s_mul_i32 s53, s40, 5
    s_min_u32 s53, s53, 15
    s_lshl_b32 s53, s53, 10
    v_lshlrev_b32 v26, 4, v1
    v_add_u32 v26, s53, v26
    global_load_dwordx4 v[6:9], v26, s[72:73]
    v_add_u32 v26, 0x400, v26
    global_load_dwordx4 v[6:9], v26, s[72:73]
    v_add_u32 v26, 0x400, v26
    global_load_dwordx4 v[6:9], v26, s[72:73]
    v_add_u32 v26, 0x400, v26
    global_load_dwordx4 v[6:9], v26, s[72:73]
    v_add_u32 v26, 0x400, v26
    global_load_dwordx4 v[6:9], v26, s[72:73]
    ds_read_b128 v[224:227], v20 offset:6144
    ds_read_b128 v[228:231], v21 offset:6144
    ds_read_b128 v[232:235], v22 offset:6144
    ds_read_b128 v[236:239], v23 offset:6144
    ds_read_b128 v[240:243], v20 offset:7168
    ds_read_b128 v[244:247], v21 offset:7168
    ds_read_b128 v[248:251], v22 offset:7168
    ds_read_b128 v[252:255], v23 offset:7168
    s_waitcnt lgkmcnt(4)
    v_mfma_f32_16x16x32_bf16 v[44:47], v[40:43], v[224:227], v[44:47]
    v_dot2c_f32_bf16 v48, v224, v224
    v_dot2c_f32_bf16 v49, v225, v225
    v_dot2c_f32_bf16 v48, v226, v226
    v_dot2c_f32_bf16 v49, v227, v227
    v_mfma_f32_16x16x32_bf16 v[44:47], v[40:43], v[228:231], v[44:47]
    v_dot2c_f32_bf16 v48, v228, v228
    v_dot2c_f32_bf16 v49, v229, v229
    v_dot2c_f32_bf16 v48, v230, v230
    v_dot2c_f32_bf16 v49, v231, v231
    v_mfma_f32_16x16x32_bf16 v[44:47], v[40:43], v[232:235], v[44:47]
    v_dot2c_f32_bf16 v48, v232, v232
    v_dot2c_f32_bf16 v49, v233, v233
    v_dot2c_f32_bf16 v48, v234, v234
    v_dot2c_f32_bf16 v49, v235, v235
    v_mfma_f32_16x16x32_bf16 v[44:47], v[40:43], v[236:239], v[44:47]
    v_dot2c_f32_bf16 v48, v236, v236
    v_dot2c_f32_bf16 v49, v237, v237
    v_dot2c_f32_bf16 v48, v238, v238
    v_dot2c_f32_bf16 v49, v239, v239
    s_waitcnt lgkmcnt(0)
    s_barrier
    v_mfma_f32_16x16x32_bf16 v[44:47], v[40:43], v[240:243], v[44:47]
    v_dot2c_f32_bf16 v48, v240, v240
    v_dot2c_f32_bf16 v49, v241, v241
    v_dot2c_f32_bf16 v48, v242, v242
    v_dot2c_f32_bf16 v49, v243, v243
    v_mfma_f32_16x16x32_bf16 v[44:47], v[40:43], v[244:247], v[44:47]
    v_dot2c_f32_bf16 v48, v244, v244
    v_dot2c_f32_bf16 v49, v245, v245
    v_dot2c_f32_bf16 v48, v246, v246
    v_dot2c_f32_bf16 v49, v247, v247
    v_mfma_f32_16x16x32_bf16 v[44:47], v[40:43], v[248:251], v[44:47]
    v_dot2c_f32_bf16 v48, v248, v248
    v_dot2c_f32_bf16 v49, v249, v249
    v_dot2c_f32_bf16 v48, v250, v250
    v_dot2c_f32_bf16 v49, v251, v251
    v_mfma_f32_16x16x32_bf16 v[44:47], v[40:43], v[252:255], v[44:47]
    v_dot2c_f32_bf16 v48, v252, v252
    v_dot2c_f32_bf16 v49, v253, v253
    v_dot2c_f32_bf16 v48, v254, v254
    v_dot2c_f32_bf16 v49, v255, v255
    s_nop 2
    v_add_f32 v48, v48, v49
    s_mov_b32 s53, 0xbb000000
    v_mov_b32 v49, v48
    s_nop 1
    v_permlane32_swap_b32 v48, v49
    v_mul_f32 v44, s53, v44
    v_mul_f32 v45, s53, v45
    v_mul_f32 v46, s53, v46
    v_mul_f32 v47, s53, v47
    v_add_f32 v48, v48, v49
    v_mul_f32 v48, s53, v48
    v_fma_f32 v48, -v44, v44, -v48
    v_max_f32 v48, 0, v48
    v_add_f32 v48, 0x3727c5ac, v48
    v_rsq_f32 v12, v48
    v_mfma_f32_16x16x32_bf16 v[64:67], v[36:39], v[128:131], v[44:47]
    v_mfma_f32_16x16x32_bf16 v[68:71], v[34:37], v[128:131], v[44:47]
    v_mfma_f32_16x16x32_bf16 v[72:75], v[36:39], v[132:135], v[44:47]
    v_mfma_f32_16x16x32_bf16 v[76:79], v[34:37], v[132:135], v[44:47]
    v_mul_f32 v15, 0x3eb8aa3b, v12
    v_mul_f32 v13, v12, v12
    v_mfma_f32_16x16x32_bf16 v[80:83], v[36:39], v[136:139], v[44:47]
    v_mfma_f32_16x16x32_bf16 v[84:87], v[34:37], v[136:139], v[44:47]
    s_nop 1
    v_cvt_pk_bf16_f32 v128, v64, v65
    v_cvt_pk_bf16_f32 v129, v66, v67
    v_cvt_pk_bf16_f32 v130, v68, v69
    v_cvt_pk_bf16_f32 v131, v70, v71
    v_mfma_f32_16x16x32_bf16 v[64:67], v[36:39], v[140:143], v[44:47]
    v_mfma_f32_16x16x32_bf16 v[68:71], v[34:37], v[140:143], v[44:47]
    v_cvt_pk_bf16_f32 v132, v72, v73
    v_cvt_pk_bf16_f32 v133, v74, v75
    v_cvt_pk_bf16_f32 v134, v76, v77
    v_cvt_pk_bf16_f32 v135, v78, v79
    v_mfma_f32_16x16x32_bf16 v[72:75], v[36:39], v[144:147], v[44:47]
    v_mfma_f32_16x16x32_bf16 v[76:79], v[34:37], v[144:147], v[44:47]
    v_cvt_pk_bf16_f32 v136, v80, v81
    v_cvt_pk_bf16_f32 v137, v82, v83
    v_cvt_pk_bf16_f32 v138, v84, v85
    v_cvt_pk_bf16_f32 v139, v86, v87
    v_mfma_f32_16x16x32_bf16 v[80:83], v[36:39], v[148:151], v[44:47]
    v_mfma_f32_16x16x32_bf16 v[84:87], v[34:37], v[148:151], v[44:47]
    v_cvt_pk_bf16_f32 v140, v64, v65
    v_cvt_pk_bf16_f32 v141, v66, v67
    v_cvt_pk_bf16_f32 v142, v68, v69
    v_cvt_pk_bf16_f32 v143, v70, v71
    v_mfma_f32_16x16x32_bf16 v[64:67], v[36:39], v[152:155], v[44:47]
    v_mfma_f32_16x16x32_bf16 v[68:71], v[34:37], v[152:155], v[44:47]
    v_cvt_pk_bf16_f32 v144, v72, v73
    v_cvt_pk_bf16_f32 v145, v74, v75
    v_cvt_pk_bf16_f32 v146, v76, v77
    v_cvt_pk_bf16_f32 v147, v78, v79
    v_mfma_f32_16x16x32_bf16 v[72:75], v[36:39], v[156:159], v[44:47]
    v_mfma_f32_16x16x32_bf16 v[76:79], v[34:37], v[156:159], v[44:47]
    v_cvt_pk_bf16_f32 v148, v80, v81
    v_cvt_pk_bf16_f32 v149, v82, v83
    v_cvt_pk_bf16_f32 v150, v84, v85
    v_cvt_pk_bf16_f32 v151, v86, v87
    v_mfma_f32_16x16x32_bf16 v[80:83], v[36:39], v[160:163], v[44:47]
    v_mfma_f32_16x16x32_bf16 v[84:87], v[34:37], v[160:163], v[44:47]
    v_cvt_pk_bf16_f32 v152, v64, v65
    v_cvt_pk_bf16_f32 v153, v66, v67
    v_cvt_pk_bf16_f32 v154, v68, v69
    v_cvt_pk_bf16_f32 v155, v70, v71
    v_mfma_f32_16x16x32_bf16 v[64:67], v[36:39], v[164:167], v[44:47]
    v_mfma_f32_16x16x32_bf16 v[68:71], v[34:37], v[164:167], v[44:47]
    v_cvt_pk_bf16_f32 v156, v72, v73
    v_cvt_pk_bf16_f32 v157, v74, v75
    v_cvt_pk_bf16_f32 v158, v76, v77
    v_cvt_pk_bf16_f32 v159, v78, v79
    v_mfma_f32_16x16x32_bf16 v[72:75], v[36:39], v[168:171], v[44:47]
    v_mfma_f32_16x16x32_bf16 v[76:79], v[34:37], v[168:171], v[44:47]
    v_cvt_pk_bf16_f32 v160, v80, v81
    v_cvt_pk_bf16_f32 v161, v82, v83
    v_cvt_pk_bf16_f32 v162, v84, v85
    v_cvt_pk_bf16_f32 v163, v86, v87
    v_mfma_f32_16x16x32_bf16 v[80:83], v[36:39], v[172:175], v[44:47]
    v_mfma_f32_16x16x32_bf16 v[84:87], v[34:37], v[172:175], v[44:47]
    v_cvt_pk_bf16_f32 v164, v64, v65
    v_cvt_pk_bf16_f32 v165, v66, v67
    v_cvt_pk_bf16_f32 v166, v68, v69
    v_cvt_pk_bf16_f32 v167, v70, v71
    v_mfma_f32_16x16x32_bf16 v[64:67], v[36:39], v[176:179], v[44:47]
    v_mfma_f32_16x16x32_bf16 v[68:71], v[34:37], v[176:179], v[44:47]
    v_cvt_pk_bf16_f32 v168, v72, v73
    v_cvt_pk_bf16_f32 v169, v74, v75
    v_cvt_pk_bf16_f32 v170, v76, v77
    v_cvt_pk_bf16_f32 v171, v78, v79
    v_mfma_f32_16x16x32_bf16 v[72:75], v[36:39], v[180:183], v[44:47]
    v_mfma_f32_16x16x32_bf16 v[76:79], v[34:37], v[180:183], v[44:47]
    v_cvt_pk_bf16_f32 v172, v80, v81
    v_cvt_pk_bf16_f32 v173, v82, v83
    v_cvt_pk_bf16_f32 v174, v84, v85
    v_cvt_pk_bf16_f32 v175, v86, v87
    v_mfma_f32_16x16x32_bf16 v[80:83], v[36:39], v[184:187], v[44:47]
    v_mfma_f32_16x16x32_bf16 v[84:87], v[34:37], v[184:187], v[44:47]
    v_cvt_pk_bf16_f32 v176, v64, v65
    v_cvt_pk_bf16_f32 v177, v66, v67
    v_cvt_pk_bf16_f32 v178, v68, v69
    v_cvt_pk_bf16_f32 v179, v70, v71
    v_mfma_f32_16x16x32_bf16 v[64:67], v[36:39], v[188:191], v[44:47]
    v_mfma_f32_16x16x32_bf16 v[68:71], v[34:37], v[188:191], v[44:47]
    v_cvt_pk_bf16_f32 v180, v72, v73
    v_cvt_pk_bf16_f32 v181, v74, v75
    v_cvt_pk_bf16_f32 v182, v76, v77
    v_cvt_pk_bf16_f32 v183, v78, v79
    v_mfma_f32_16x16x32_bf16 v[72:75], v[36:39], v[192:195], v[44:47]
    v_mfma_f32_16x16x32_bf16 v[76:79], v[34:37], v[192:195], v[44:47]
    v_cvt_pk_bf16_f32 v184, v80, v81
    v_cvt_pk_bf16_f32 v185, v82, v83
    v_cvt_pk_bf16_f32 v186, v84, v85
    v_cvt_pk_bf16_f32 v187, v86, v87
    v_mfma_f32_16x16x32_bf16 v[80:83], v[36:39], v[196:199], v[44:47]
    v_mfma_f32_16x16x32_bf16 v[84:87], v[34:37], v[196:199], v[44:47]
    v_cvt_pk_bf16_f32 v188, v64, v65
    v_cvt_pk_bf16_f32 v189, v66, v67
    v_cvt_pk_bf16_f32 v190, v68, v69
    v_cvt_pk_bf16_f32 v191, v70, v71
    v_mfma_f32_16x16x32_bf16 v[64:67], v[36:39], v[200:203], v[44:47]
    v_mfma_f32_16x16x32_bf16 v[68:71], v[34:37], v[200:203], v[44:47]
    v_cvt_pk_bf16_f32 v192, v72, v73
    v_cvt_pk_bf16_f32 v193, v74, v75
    v_cvt_pk_bf16_f32 v194, v76, v77
    v_cvt_pk_bf16_f32 v195, v78, v79
    v_mfma_f32_16x16x32_bf16 v[72:75], v[36:39], v[204:207], v[44:47]
    v_mfma_f32_16x16x32_bf16 v[76:79], v[34:37], v[204:207], v[44:47]
    v_cvt_pk_bf16_f32 v196, v80, v81
    v_cvt_pk_bf16_f32 v197, v82, v83
    v_cvt_pk_bf16_f32 v198, v84, v85
    v_cvt_pk_bf16_f32 v199, v86, v87
    v_mfma_f32_16x16x32_bf16 v[80:83], v[36:39], v[208:211], v[44:47]
    v_mfma_f32_16x16x32_bf16 v[84:87], v[34:37], v[208:211], v[44:47]
    v_cvt_pk_bf16_f32 v200, v64, v65
    v_cvt_pk_bf16_f32 v201, v66, v67
    v_cvt_pk_bf16_f32 v202, v68, v69
    v_cvt_pk_bf16_f32 v203, v70, v71
    v_mfma_f32_16x16x32_bf16 v[64:67], v[36:39], v[212:215], v[44:47]
    v_mfma_f32_16x16x32_bf16 v[68:71], v[34:37], v[212:215], v[44:47]
    v_cvt_pk_bf16_f32 v204, v72, v73
    v_cvt_pk_bf16_f32 v205, v74, v75
    v_cvt_pk_bf16_f32 v206, v76, v77
    v_cvt_pk_bf16_f32 v207, v78, v79
    v_mfma_f32_16x16x32_bf16 v[72:75], v[36:39], v[216:219], v[44:47]
    v_mfma_f32_16x16x32_bf16 v[76:79], v[34:37], v[216:219], v[44:47]
    v_cvt_pk_bf16_f32 v208, v80, v81
    v_cvt_pk_bf16_f32 v209, v82, v83
    v_cvt_pk_bf16_f32 v210, v84, v85
    v_cvt_pk_bf16_f32 v211, v86, v87
    v_mfma_f32_16x16x32_bf16 v[80:83], v[36:39], v[220:223], v[44:47]
    v_mfma_f32_16x16x32_bf16 v[84:87], v[34:37], v[220:223], v[44:47]
    v_cvt_pk_bf16_f32 v212, v64, v65
    v_cvt_pk_bf16_f32 v213, v66, v67
    v_cvt_pk_bf16_f32 v214, v68, v69
    v_cvt_pk_bf16_f32 v215, v70, v71
    v_mfma_f32_16x16x32_bf16 v[64:67], v[36:39], v[224:227], v[44:47]
    v_mfma_f32_16x16x32_bf16 v[68:71], v[34:37], v[224:227], v[44:47]
    v_cvt_pk_bf16_f32 v216, v72, v73
    v_cvt_pk_bf16_f32 v217, v74, v75
    v_cvt_pk_bf16_f32 v218, v76, v77
    v_cvt_pk_bf16_f32 v219, v78, v79
    v_mfma_f32_16x16x32_bf16 v[72:75], v[36:39], v[228:231], v[44:47]
    v_mfma_f32_16x16x32_bf16 v[76:79], v[34:37], v[228:231], v[44:47]
    v_cvt_pk_bf16_f32 v220, v80, v81
    v_cvt_pk_bf16_f32 v221, v82, v83
    v_cvt_pk_bf16_f32 v222, v84, v85
    v_cvt_pk_bf16_f32 v223, v86, v87
    v_mfma_f32_16x16x32_bf16 v[80:83], v[36:39], v[232:235], v[44:47]
    v_mfma_f32_16x16x32_bf16 v[84:87], v[34:37], v[232:235], v[44:47]
    v_cvt_pk_bf16_f32 v224, v64, v65
    v_cvt_pk_bf16_f32 v225, v66, v67
    v_cvt_pk_bf16_f32 v226, v68, v69
    v_cvt_pk_bf16_f32 v227, v70, v71
    v_mfma_f32_16x16x32_bf16 v[64:67], v[36:39], v[236:239], v[44:47]
    v_mfma_f32_16x16x32_bf16 v[68:71], v[34:37], v[236:239], v[44:47]
    v_cvt_pk_bf16_f32 v228, v72, v73
    v_cvt_pk_bf16_f32 v229, v74, v75
    v_cvt_pk_bf16_f32 v230, v76, v77
    v_cvt_pk_bf16_f32 v231, v78, v79
    v_mfma_f32_16x16x32_bf16 v[72:75], v[36:39], v[240:243], v[44:47]
    v_mfma_f32_16x16x32_bf16 v[76:79], v[34:37], v[240:243], v[44:47]
    v_cvt_pk_bf16_f32 v232, v80, v81
    v_cvt_pk_bf16_f32 v233, v82, v83
    v_cvt_pk_bf16_f32 v234, v84, v85
    v_cvt_pk_bf16_f32 v235, v86, v87
    v_mfma_f32_16x16x32_bf16 v[80:83], v[36:39], v[244:247], v[44:47]
    v_mfma_f32_16x16x32_bf16 v[84:87], v[34:37], v[244:247], v[44:47]
    v_cvt_pk_bf16_f32 v236, v64, v65
    v_cvt_pk_bf16_f32 v237, v66, v67
    v_cvt_pk_bf16_f32 v238, v68, v69
    v_cvt_pk_bf16_f32 v239, v70, v71
    v_mfma_f32_16x16x32_bf16 v[64:67], v[36:39], v[248:251], v[44:47]
    v_mfma_f32_16x16x32_bf16 v[68:71], v[34:37], v[248:251], v[44:47]
    v_cvt_pk_bf16_f32 v240, v72, v73
    v_cvt_pk_bf16_f32 v241, v74, v75
    v_cvt_pk_bf16_f32 v242, v76, v77
    v_cvt_pk_bf16_f32 v243, v78, v79
    v_mfma_f32_16x16x32_bf16 v[72:75], v[36:39], v[252:255], v[44:47]
    v_mfma_f32_16x16x32_bf16 v[76:79], v[34:37], v[252:255], v[44:47]
    v_cvt_pk_bf16_f32 v244, v80, v81
    v_cvt_pk_bf16_f32 v245, v82, v83
    v_cvt_pk_bf16_f32 v246, v84, v85
    v_cvt_pk_bf16_f32 v247, v86, v87
    s_nop 3
    v_cvt_pk_bf16_f32 v248, v64, v65
    v_cvt_pk_bf16_f32 v249, v66, v67
    v_cvt_pk_bf16_f32 v250, v68, v69
    v_cvt_pk_bf16_f32 v251, v70, v71
    s_nop 3
    v_cvt_pk_bf16_f32 v252, v72, v73
    v_cvt_pk_bf16_f32 v253, v74, v75
    v_cvt_pk_bf16_f32 v254, v76, v77
    v_cvt_pk_bf16_f32 v255, v78, v79
    s_cmp_lt_u32 s40, 2
    s_cselect_b32 s68, s12, s14
    s_cselect_b32 s69, s13, s15
    s_and_b32 s69, s69, 0xffff
    s_mov_b32 s70, 0x1c0000
    s_mul_i32 s67, s2, 7168
    s_and_b32 s53, s40, 1
    s_mul_i32 s53, s53, 3584
    s_add_u32 s67, s67, s53
    buffer_load_dwordx4 v[6:9], v10, s[68:71], s67 offen offset:0
    buffer_load_dwordx4 v[6:9], v10, s[68:71], s67 offen offset:1024
    buffer_load_dwordx4 v[6:9], v10, s[68:71], s67 offen offset:2048
    buffer_load_dwordx4 v[6:9], v10, s[68:71], s67 offen offset:2560
    s_barrier
    s_mov_b32 s49, 0x18000
    v_mov_b32 v2, v4
    v_mov_b32 v3, v5
    ds_read_b64_tr_b16 v[32:33], v2 offset:0
    ds_read_b64_tr_b16 v[34:35], v2 offset:512
    ds_read_b64_tr_b16 v[36:37], v3 offset:0
    ds_read_b64_tr_b16 v[38:39], v3 offset:512
    ds_read_b64_tr_b16 v[40:41], v2 offset:2048
    ds_read_b64_tr_b16 v[42:43], v2 offset:2560
    ds_read_b64_tr_b16 v[44:45], v3 offset:2048
    ds_read_b64_tr_b16 v[46:47], v3 offset:2560
    s_mov_b32 s48, 0
    s_and_b32 s58, s44, 0xff
    s_lshr_b64 s[44:45], s[44:45], 8
L_k1_job:
    s_lshr_b32 s56, s58, 5
    s_and_b32 s57, s58, 31
    s_cmp_eq_u32 s56, 2
    s_cbranch_scc1 L_k1_chainU
    s_and_b32 s53, s58, 0xf0
    s_cmp_eq_u32 s53, 16
    s_cbranch_scc1 L_k1_chainV
    ds_read_b64_tr_b16 v[48:49], v2 offset:4096
    ds_read_b64_tr_b16 v[50:51], v2 offset:4608
    s_waitcnt lgkmcnt(6)
    v_mfma_f32_32x32x16_bf16 v[64:79], v[32:35], v[128:131], 0
    ds_read_b64_tr_b16 v[52:53], v3 offset:4096
    ds_read_b64_tr_b16 v[54:55], v3 offset:4608
    v_mfma_f32_32x32x16_bf16 v[80:95], v[36:39], v[128:131], 0
    ds_read_b64_tr_b16 v[56:57], v2 offset:6144
    ds_read_b64_tr_b16 v[58:59], v2 offset:6656
    s_waitcnt lgkmcnt(6)
    v_mfma_f32_32x32x16_bf16 v[64:79], v[40:43], v[132:135], v[64:79]
    ds_read_b64_tr_b16 v[60:61], v3 offset:6144
    ds_read_b64_tr_b16 v[62:63], v3 offset:6656
    v_mfma_f32_32x32x16_bf16 v[80:95], v[44:47], v[132:135], v[80:95]
    ds_read_b64_tr_b16 v[32:33], v2 offset:8192
    ds_read_b64_tr_b16 v[34:35], v2 offset:8704
    s_waitcnt lgkmcnt(6)
    v_mfma_f32_32x32x16_bf16 v[64:79], v[48:51], v[136:139], v[64:79]
    ds_read_b64_tr_b16 v[36:37], v3 offset:8192
    ds_read_b64_tr_b16 v[38:39], v3 offset:8704
    s_barrier
    v_mfma_f32_32x32x16_bf16 v[80:95], v[52:55], v[136:139], v[80:95]
    ds_read_b64_tr_b16 v[40:41], v2 offset:10240
    ds_read_b64_tr_b16 v[42:43], v2 offset:10752
    s_waitcnt lgkmcnt(6)
    v_mfma_f32_32x32x16_bf16 v[64:79], v[56:59], v[140:143], v[64:79]
    ds_read_b64_tr_b16 v[44:45], v3 offset:10240
    ds_read_b64_tr_b16 v[46:47], v3 offset:10752
    v_mfma_f32_32x32x16_bf16 v[80:95], v[60:63], v[140:143], v[80:95]
    ds_read_b64_tr_b16 v[48:49], v2 offset:12288
    ds_read_b64_tr_b16 v[50:51], v2 offset:12800
    s_waitcnt lgkmcnt(6)
    v_mfma_f32_32x32x16_bf16 v[64:79], v[32:35], v[144:147], v[64:79]
    ds_read_b64_tr_b16 v[52:53], v3 offset:12288
    ds_read_b64_tr_b16 v[54:55], v3 offset:12800
    v_mfma_f32_32x32x16_bf16 v[80:95], v[36:39], v[144:147], v[80:95]
    ds_read_b64_tr_b16 v[56:57], v2 offset:14336
    ds_read_b64_tr_b16 v[58:59], v2 offset:14848
    s_waitcnt lgkmcnt(6)
    v_mfma_f32_32x32x16_bf16 v[64:79], v[40:43], v[148:151], v[64:79]
    ds_read_b64_tr_b16 v[60:61], v3 offset:14336
    ds_read_b64_tr_b16 v[62:63], v3 offset:14848
    v_mfma_f32_32x32x16_bf16 v[80:95], v[44:47], v[148:151], v[80:95]
    ds_read_b64_tr_b16 v[32:33], v2 offset:16384
    ds_read_b64_tr_b16 v[34:35], v2 offset:16896
    s_waitcnt lgkmcnt(6)
    v_mfma_f32_32x32x16_bf16 v[64:79], v[48:51], v[152:155], v[64:79]
    ds_read_b64_tr_b16 v[36:37], v3 offset:16384
    ds_read_b64_tr_b16 v[38:39], v3 offset:16896
    v_mfma_f32_32x32x16_bf16 v[80:95], v[52:55], v[152:155], v[80:95]
    ds_read_b64_tr_b16 v[40:41], v2 offset:18432
    ds_read_b64_tr_b16 v[42:43], v2 offset:18944
    s_waitcnt lgkmcnt(6)
    v_mfma_f32_32x32x16_bf16 v[64:79], v[56:59], v[156:159], v[64:79]
    ds_read_b64_tr_b16 v[44:45], v3 offset:18432
    ds_read_b64_tr_b16 v[46:47], v3 offset:18944
    v_mfma_f32_32x32x16_bf16 v[80:95], v[60:63], v[156:159], v[80:95]
    ds_read_b64_tr_b16 v[48:49], v2 offset:20480
    ds_read_b64_tr_b16 v[50:51], v2 offset:20992
    s_waitcnt lgkmcnt(6)
    v_mfma_f32_32x32x16_bf16 v[64:79], v[32:35], v[160:163], v[64:79]
    ds_read_b64_tr_b16 v[52:53], v3 offset:20480
    ds_read_b64_tr_b16 v[54:55], v3 offset:20992
    v_mfma_f32_32x32x16_bf16 v[80:95], v[36:39], v[160:163], v[80:95]
    ds_read_b64_tr_b16 v[56:57], v2 offset:22528
    ds_read_b64_tr_b16 v[58:59], v2 offset:23040
    s_waitcnt lgkmcnt(6)
    v_mfma_f32_32x32x16_bf16 v[64:79], v[40:43], v[164:167], v[64:79]
    ds_read_b64_tr_b16 v[60:61], v3 offset:22528
    ds_read_b64_tr_b16 v[62:63], v3 offset:23040
    v_mfma_f32_32x32x16_bf16 v[80:95], v[44:47], v[164:167], v[80:95]
    ds_read_b64_tr_b16 v[32:33], v2 offset:24576
    ds_read_b64_tr_b16 v[34:35], v2 offset:25088
    s_waitcnt lgkmcnt(6)
    v_mfma_f32_32x32x16_bf16 v[64:79], v[48:51], v[168:171], v[64:79]
    ds_read_b64_tr_b16 v[36:37], v3 offset:24576
    ds_read_b64_tr_b16 v[38:39], v3 offset:25088
    v_mfma_f32_32x32x16_bf16 v[80:95], v[52:55], v[168:171], v[80:95]
    ds_read_b64_tr_b16 v[40:41], v2 offset:26624
    ds_read_b64_tr_b16 v[42:43], v2 offset:27136
    s_waitcnt lgkmcnt(6)
    v_mfma_f32_32x32x16_bf16 v[64:79], v[56:59], v[172:175], v[64:79]
    ds_read_b64_tr_b16 v[44:45], v3 offset:26624
    ds_read_b64_tr_b16 v[46:47], v3 offset:27136
    v_mfma_f32_32x32x16_bf16 v[80:95], v[60:63], v[172:175], v[80:95]
    ds_read_b64_tr_b16 v[48:49], v2 offset:28672
    ds_read_b64_tr_b16 v[50:51], v2 offset:29184
    s_waitcnt lgkmcnt(6)
    v_mfma_f32_32x32x16_bf16 v[64:79], v[32:35], v[176:179], v[64:79]
    ds_read_b64_tr_b16 v[52:53], v3 offset:28672
    ds_read_b64_tr_b16 v[54:55], v3 offset:29184
    v_mfma_f32_32x32x16_bf16 v[80:95], v[36:39], v[176:179], v[80:95]
    ds_read_b64_tr_b16 v[56:57], v2 offset:30720
    ds_read_b64_tr_b16 v[58:59], v2 offset:31232
    s_waitcnt lgkmcnt(6)
    v_mfma_f32_32x32x16_bf16 v[64:79], v[40:43], v[180:183], v[64:79]
    ds_read_b64_tr_b16 v[60:61], v3 offset:30720
    ds_read_b64_tr_b16 v[62:63], v3 offset:31232
    v_mfma_f32_32x32x16_bf16 v[80:95], v[44:47], v[180:183], v[80:95]
    s_add_u32 s49, s49, 0x8000
    s_cmp_eq_u32 s49, 0x28000
    s_cselect_b32 s49, 0x8000, s49
    v_add_u32 v2, s49, v4
    v_add_u32 v3, s49, v5
    ds_read_b64_tr_b16 v[32:33], v2 offset:0
    ds_read_b64_tr_b16 v[34:35], v2 offset:512
    s_waitcnt lgkmcnt(6)
    v_mfma_f32_32x32x16_bf16 v[64:79], v[48:51], v[184:187], v[64:79]
    ds_read_b64_tr_b16 v[36:37], v3 offset:0
    ds_read_b64_tr_b16 v[38:39], v3 offset:512
    v_mfma_f32_32x32x16_bf16 v[80:95], v[52:55], v[184:187], v[80:95]
    ds_read_b64_tr_b16 v[40:41], v2 offset:2048
    ds_read_b64_tr_b16 v[42:43], v2 offset:2560
    s_waitcnt lgkmcnt(6)
    v_mfma_f32_32x32x16_bf16 v[64:79], v[56:59], v[188:191], v[64:79]
    ds_read_b64_tr_b16 v[44:45], v3 offset:2048
    ds_read_b64_tr_b16 v[46:47], v3 offset:2560
    v_mfma_f32_32x32x16_bf16 v[80:95], v[60:63], v[188:191], v[80:95]
    ds_read_b64_tr_b16 v[48:49], v2 offset:4096
    ds_read_b64_tr_b16 v[50:51], v2 offset:4608
    s_waitcnt lgkmcnt(6)
    v_mfma_f32_32x32x16_bf16 v[64:79], v[32:35], v[192:195], v[64:79]
    ds_read_b64_tr_b16 v[52:53], v3 offset:4096
    ds_read_b64_tr_b16 v[54:55], v3 offset:4608
    s_and_b32 s58, s44, 0xff
    v_mfma_f32_32x32x16_bf16 v[80:95], v[36:39], v[192:195], v[80:95]
    s_lshr_b64 s[44:45], s[44:45], 8
    ds_read_b64_tr_b16 v[56:57], v2 offset:6144
    ds_read_b64_tr_b16 v[58:59], v2 offset:6656
    s_waitcnt lgkmcnt(6)
    v_mfma_f32_32x32x16_bf16 v[64:79], v[40:43], v[196:199], v[64:79]
    ds_read_b64_tr_b16 v[60:61], v3 offset:6144
    ds_read_b64_tr_b16 v[62:63], v3 offset:6656
    s_lshr_b32 s53, s57, 3
    v_mfma_f32_32x32x16_bf16 v[80:95], v[44:47], v[196:199], v[80:95]
    s_lshl_b32 s53, s53, 21
    ds_read_b64_tr_b16 v[32:33], v2 offset:8192
    ds_read_b64_tr_b16 v[34:35], v2 offset:8704
    s_waitcnt lgkmcnt(6)
    v_mfma_f32_32x32x16_bf16 v[64:79], v[48:51], v[200:203], v[64:79]
    ds_read_b64_tr_b16 v[36:37], v3 offset:8192
    ds_read_b64_tr_b16 v[38:39], v3 offset:8704
    s_waitcnt vmcnt(0)
    s_barrier
    v_mfma_f32_32x32x16_bf16 v[80:95], v[52:55], v[200:203], v[80:95]
    s_and_b32 s54, s57, 7
    ds_read_b64_tr_b16 v[40:41], v2 offset:10240
    ds_read_b64_tr_b16 v[42:43], v2 offset:10752
    s_waitcnt lgkmcnt(6)
    v_mfma_f32_32x32x16_bf16 v[64:79], v[56:59], v[204:207], v[64:79]
    ds_read_b64_tr_b16 v[44:45], v3 offset:10240
    ds_read_b64_tr_b16 v[46:47], v3 offset:10752
    s_lshl_b32 s54, s54, 8
    v_mfma_f32_32x32x16_bf16 v[80:95], v[60:63], v[204:207], v[80:95]
    s_add_u32 s54, s54, s41
    ds_read_b64_tr_b16 v[48:49], v2 offset:12288
    ds_read_b64_tr_b16 v[50:51], v2 offset:12800
    s_waitcnt lgkmcnt(6)
    v_mfma_f32_32x32x16_bf16 v[64:79], v[32:35], v[208:211], v[64:79]
    ds_read_b64_tr_b16 v[52:53], v3 offset:12288
    ds_read_b64_tr_b16 v[54:55], v3 offset:12800
    s_lshl_b32 s54, s54, 10
    v_mfma_f32_32x32x16_bf16 v[80:95], v[36:39], v[208:211], v[80:95]
    s_add_u32 s66, s53, s54
    ds_read_b64_tr_b16 v[56:57], v2 offset:14336
    ds_read_b64_tr_b16 v[58:59], v2 offset:14848
    s_waitcnt lgkmcnt(6)
    v_mfma_f32_32x32x16_bf16 v[64:79], v[40:43], v[212:215], v[64:79]
    ds_read_b64_tr_b16 v[60:61], v3 offset:14336
    ds_read_b64_tr_b16 v[62:63], v3 offset:14848
    v_mfma_f32_32x32x16_bf16 v[80:95], v[44:47], v[212:215], v[80:95]
    ds_read_b64_tr_b16 v[32:33], v2 offset:16384
    ds_read_b64_tr_b16 v[34:35], v2 offset:16896
    s_waitcnt lgkmcnt(6)
    v_mfma_f32_32x32x16_bf16 v[64:79], v[48:51], v[216:219], v[64:79]
    ds_read_b64_tr_b16 v[36:37], v3 offset:16384
    ds_read_b64_tr_b16 v[38:39], v3 offset:16896
    v_mfma_f32_32x32x16_bf16 v[80:95], v[52:55], v[216:219], v[80:95]
    ds_read_b64_tr_b16 v[40:41], v2 offset:18432
    ds_read_b64_tr_b16 v[42:43], v2 offset:18944
    s_waitcnt lgkmcnt(6)
    v_mfma_f32_32x32x16_bf16 v[64:79], v[56:59], v[220:223], v[64:79]
    ds_read_b64_tr_b16 v[44:45], v3 offset:18432
    ds_read_b64_tr_b16 v[46:47], v3 offset:18944
    v_mfma_f32_32x32x16_bf16 v[80:95], v[60:63], v[220:223], v[80:95]
    ds_read_b64_tr_b16 v[48:49], v2 offset:20480
    ds_read_b64_tr_b16 v[50:51], v2 offset:20992
    s_waitcnt lgkmcnt(6)
    v_mfma_f32_32x32x16_bf16 v[64:79], v[32:35], v[224:227], v[64:79]
    ds_read_b64_tr_b16 v[52:53], v3 offset:20480
    ds_read_b64_tr_b16 v[54:55], v3 offset:20992
    v_mfma_f32_32x32x16_bf16 v[80:95], v[36:39], v[224:227], v[80:95]
    ds_read_b64_tr_b16 v[56:57], v2 offset:22528
    ds_read_b64_tr_b16 v[58:59], v2 offset:23040
    s_waitcnt lgkmcnt(6)
    v_mfma_f32_32x32x16_bf16 v[64:79], v[40:43], v[228:231], v[64:79]
    ds_read_b64_tr_b16 v[60:61], v3 offset:22528
    ds_read_b64_tr_b16 v[62:63], v3 offset:23040
    v_mfma_f32_32x32x16_bf16 v[80:95], v[44:47], v[228:231], v[80:95]
    ds_read_b64_tr_b16 v[32:33], v2 offset:24576
    ds_read_b64_tr_b16 v[34:35], v2 offset:25088
    s_waitcnt lgkmcnt(6)
    v_mfma_f32_32x32x16_bf16 v[64:79], v[48:51], v[232:235], v[64:79]
    ds_read_b64_tr_b16 v[36:37], v3 offset:24576
    ds_read_b64_tr_b16 v[38:39], v3 offset:25088
    v_mfma_f32_32x32x16_bf16 v[80:95], v[52:55], v[232:235], v[80:95]
    ds_read_b64_tr_b16 v[40:41], v2 offset:26624
    ds_read_b64_tr_b16 v[42:43], v2 offset:27136
    s_waitcnt lgkmcnt(6)
    v_mfma_f32_32x32x16_bf16 v[64:79], v[56:59], v[236:239], v[64:79]
    ds_read_b64_tr_b16 v[44:45], v3 offset:26624
    ds_read_b64_tr_b16 v[46:47], v3 offset:27136
    v_mfma_f32_32x32x16_bf16 v[80:95], v[60:63], v[236:239], v[80:95]
    ds_read_b64_tr_b16 v[48:49], v2 offset:28672
    ds_read_b64_tr_b16 v[50:51], v2 offset:29184
    s_waitcnt lgkmcnt(6)
    v_mfma_f32_32x32x16_bf16 v[64:79], v[32:35], v[240:243], v[64:79]
    ds_read_b64_tr_b16 v[52:53], v3 offset:28672
    ds_read_b64_tr_b16 v[54:55], v3 offset:29184
    v_mfma_f32_32x32x16_bf16 v[80:95], v[36:39], v[240:243], v[80:95]
    ds_read_b64_tr_b16 v[56:57], v2 offset:30720
    ds_read_b64_tr_b16 v[58:59], v2 offset:31232
    s_waitcnt lgkmcnt(6)
    v_mfma_f32_32x32x16_bf16 v[64:79], v[40:43], v[244:247], v[64:79]
    ds_read_b64_tr_b16 v[60:61], v3 offset:30720
    ds_read_b64_tr_b16 v[62:63], v3 offset:31232
    v_mfma_f32_32x32x16_bf16 v[80:95], v[44:47], v[244:247], v[80:95]
    s_add_u32 s49, s49, 0x8000
    s_cmp_eq_u32 s49, 0x28000
    s_cselect_b32 s49, 0x8000, s49
    v_add_u32 v2, s49, v4
    v_add_u32 v3, s49, v5
    ds_read_b64_tr_b16 v[32:33], v2 offset:0
    ds_read_b64_tr_b16 v[34:35], v2 offset:512
    s_waitcnt lgkmcnt(2)
    v_mfma_f32_32x32x16_bf16 v[64:79], v[48:51], v[248:251], v[64:79]
    ds_read_b64_tr_b16 v[36:37], v3 offset:0
    ds_read_b64_tr_b16 v[38:39], v3 offset:512
    v_mfma_f32_32x32x16_bf16 v[64:79], v[56:59], v[252:255], v[64:79]
    ds_read_b64_tr_b16 v[40:41], v2 offset:2048
    ds_read_b64_tr_b16 v[42:43], v2 offset:2560
    v_mfma_f32_32x32x16_bf16 v[80:95], v[52:55], v[248:251], v[80:95]
    ds_read_b64_tr_b16 v[44:45], v3 offset:2048
    ds_read_b64_tr_b16 v[46:47], v3 offset:2560
    v_mfma_f32_32x32x16_bf16 v[80:95], v[60:63], v[252:255], v[80:95]
    s_cmp_eq_u32 s56, 1
    s_cbranch_scc1 L_k1_nextG
    s_cmp_lt_u32 s57, 8
    s_cselect_b64 vcc, -1, 0
    v_cndmask_b32 v14, v12, v15, vcc
    s_nop 0
    v_pk_mul_f32 v[64:65], v[64:65], v[14:15] op_sel_hi:[1,0]
    v_pk_mul_f32 v[66:67], v[66:67], v[14:15] op_sel_hi:[1,0]
    v_pk_mul_f32 v[68:69], v[68:69], v[14:15] op_sel_hi:[1,0]
    v_pk_mul_f32 v[70:71], v[70:71], v[14:15] op_sel_hi:[1,0]
    v_cvt_pk_bf16_f32 v16, v64, v65
    v_cvt_pk_bf16_f32 v17, v66, v67
    v_cvt_pk_bf16_f32 v18, v68, v69
    v_cvt_pk_bf16_f32 v19, v70, v71
    buffer_store_dwordx4 v[16:19], v10, s[28:31], s66 offen sc1
    s_add_u32 s66, s66, 0x10000
    v_pk_mul_f32 v[72:73], v[72:73], v[14:15] op_sel_hi:[1,0]
    v_pk_mul_f32 v[74:75], v[74:75], v[14:15] op_sel_hi:[1,0]
    v_pk_mul_f32 v[76:77], v[76:77], v[14:15] op_sel_hi:[1,0]
    v_pk_mul_f32 v[78:79], v[78:79], v[14:15] op_sel_hi:[1,0]
    v_cvt_pk_bf16_f32 v20, v72, v73
    v_cvt_pk_bf16_f32 v21, v74, v75
    v_cvt_pk_bf16_f32 v22, v76, v77
    v_cvt_pk_bf16_f32 v23, v78, v79
    buffer_store_dwordx4 v[20:23], v10, s[28:31], s66 offen sc1
    s_add_u32 s66, s66, 0x10000
    v_pk_mul_f32 v[80:81], v[80:81], v[14:15] op_sel_hi:[1,0]
    v_pk_mul_f32 v[82:83], v[82:83], v[14:15] op_sel_hi:[1,0]
    v_pk_mul_f32 v[84:85], v[84:85], v[14:15] op_sel_hi:[1,0]
    v_pk_mul_f32 v[86:87], v[86:87], v[14:15] op_sel_hi:[1,0]
    v_cvt_pk_bf16_f32 v24, v80, v81
    v_cvt_pk_bf16_f32 v25, v82, v83
    v_cvt_pk_bf16_f32 v26, v84, v85
    v_cvt_pk_bf16_f32 v27, v86, v87
    buffer_store_dwordx4 v[24:27], v10, s[28:31], s66 offen sc1
    s_add_u32 s66, s66, 0x10000
    v_pk_mul_f32 v[88:89], v[88:89], v[14:15] op_sel_hi:[1,0]
    v_pk_mul_f32 v[90:91], v[90:91], v[14:15] op_sel_hi:[1,0]
    v_pk_mul_f32 v[92:93], v[92:93], v[14:15] op_sel_hi:[1,0]
    v_pk_mul_f32 v[94:95], v[94:95], v[14:15] op_sel_hi:[1,0]
    v_cvt_pk_bf16_f32 v28, v88, v89
    v_cvt_pk_bf16_f32 v29, v90, v91
    v_cvt_pk_bf16_f32 v30, v92, v93
    v_cvt_pk_bf16_f32 v31, v94, v95
    buffer_store_dwordx4 v[28:31], v10, s[28:31], s66 offen sc1
    s_cmp_lt_u32 s57, 8
    s_cbranch_scc1 L_k1_next
    v_mul_f32 v96, v64, v64
    v_mul_f32 v97, v72, v72
    v_mul_f32 v98, v80, v80
    v_mul_f32 v99, v88, v88
    v_fmac_f32 v96, v65, v65
    v_fmac_f32 v97, v73, v73
    v_fmac_f32 v98, v81, v81
    v_fmac_f32 v99, v89, v89
    v_fmac_f32 v96, v66, v66
    v_fmac_f32 v97, v74, v74
    v_fmac_f32 v98, v82, v82
    v_fmac_f32 v99, v90, v90
    v_fmac_f32 v96, v67, v67
    v_fmac_f32 v97, v75, v75
    v_fmac_f32 v98, v83, v83
    v_fmac_f32 v99, v91, v91
    v_fmac_f32 v96, v68, v68
    v_fmac_f32 v97, v76, v76
    v_fmac_f32 v98, v84, v84
    v_fmac_f32 v99, v92, v92
    v_fmac_f32 v96, v69, v69
    v_fmac_f32 v97, v77, v77
    v_fmac_f32 v98, v85, v85
    v_fmac_f32 v99, v93, v93
    v_fmac_f32 v96, v70, v70
    v_fmac_f32 v97, v78, v78
    v_fmac_f32 v98, v86, v86
    v_fmac_f32 v99, v94, v94
    v_fmac_f32 v96, v71, v71
    v_fmac_f32 v97, v79, v79
    v_fmac_f32 v98, v87, v87
    v_fmac_f32 v99, v95, v95
    v_max3_f32 v96, v96, v97, v98
    v_max_f32 v96, v96, v99
    s_nop 1
    v_max_f32_dpp v96, v96, v96 row_ror:1 row_mask:0xf bank_mask:0xf
    s_nop 1
    v_max_f32_dpp v96, v96, v96 row_ror:2 row_mask:0xf bank_mask:0xf
    s_nop 1
    v_max_f32_dpp v96, v96, v96 row_ror:4 row_mask:0xf bank_mask:0xf
    s_nop 1
    v_max_f32_dpp v96, v96, v96 row_ror:8 row_mask:0xf bank_mask:0xf
    s_nop 0
    v_mov_b32 v97, v96
    s_nop 1
    v_permlane16_swap_b32 v96, v97
    s_nop 0
    v_max_f32 v96, v96, v97
    s_nop 0
    v_mov_b32 v97, v96
    s_and_b32 s54, s57, 7
    s_lshl_b32 s54, s54, 6
    v_permlane32_swap_b32 v96, v97
    s_add_u32 s54, s54, s41
    s_lshl_b32 s54, s54, 7
    v_add_f32 v96, v96, v97
    s_add_u32 s54, s54, 0x1c00000
    v_and_b32 v97, 31, v1
    v_lshlrev_b32 v97, 2, v97
    buffer_store_dword v96, v97, s[28:31], s54 offen sc1
    s_branch L_k1_next
L_k1_chainV:
    ds_read_b64_tr_b16 v[48:49], v2 offset:4096
    ds_read_b64_tr_b16 v[50:51], v2 offset:4608
    s_waitcnt lgkmcnt(6)
    v_mfma_f32_32x32x16_bf16 v[64:79], v[128:131], v[32:35], 0
    ds_read_b64_tr_b16 v[52:53], v3 offset:4096
    ds_read_b64_tr_b16 v[54:55], v3 offset:4608
    v_mfma_f32_32x32x16_bf16 v[80:95], v[128:131], v[36:39], 0
    ds_read_b64_tr_b16 v[56:57], v2 offset:6144
    ds_read_b64_tr_b16 v[58:59], v2 offset:6656
    s_waitcnt lgkmcnt(6)
    v_mfma_f32_32x32x16_bf16 v[64:79], v[132:135], v[40:43], v[64:79]
    ds_read_b64_tr_b16 v[60:61], v3 offset:6144
    ds_read_b64_tr_b16 v[62:63], v3 offset:6656
    v_mfma_f32_32x32x16_bf16 v[80:95], v[132:135], v[44:47], v[80:95]
    ds_read_b64_tr_b16 v[32:33], v2 offset:8192
    ds_read_b64_tr_b16 v[34:35], v2 offset:8704
    s_waitcnt lgkmcnt(6)
    v_mfma_f32_32x32x16_bf16 v[64:79], v[136:139], v[48:51], v[64:79]
    ds_read_b64_tr_b16 v[36:37], v3 offset:8192
    ds_read_b64_tr_b16 v[38:39], v3 offset:8704
    s_barrier
    v_mfma_f32_32x32x16_bf16 v[80:95], v[136:139], v[52:55], v[80:95]
    ds_read_b64_tr_b16 v[40:41], v2 offset:10240
    ds_read_b64_tr_b16 v[42:43], v2 offset:10752
    s_waitcnt lgkmcnt(6)
    v_mfma_f32_32x32x16_bf16 v[64:79], v[140:143], v[56:59], v[64:79]
    ds_read_b64_tr_b16 v[44:45], v3 offset:10240
    ds_read_b64_tr_b16 v[46:47], v3 offset:10752
    v_mfma_f32_32x32x16_bf16 v[80:95], v[140:143], v[60:63], v[80:95]
    ds_read_b64_tr_b16 v[48:49], v2 offset:12288
    ds_read_b64_tr_b16 v[50:51], v2 offset:12800
    s_waitcnt lgkmcnt(6)
    v_mfma_f32_32x32x16_bf16 v[64:79], v[144:147], v[32:35], v[64:79]
    ds_read_b64_tr_b16 v[52:53], v3 offset:12288
    ds_read_b64_tr_b16 v[54:55], v3 offset:12800
    v_mfma_f32_32x32x16_bf16 v[80:95], v[144:147], v[36:39], v[80:95]
    ds_read_b64_tr_b16 v[56:57], v2 offset:14336
    ds_read_b64_tr_b16 v[58:59], v2 offset:14848
    s_waitcnt lgkmcnt(6)
    v_mfma_f32_32x32x16_bf16 v[64:79], v[148:151], v[40:43], v[64:79]
    ds_read_b64_tr_b16 v[60:61], v3 offset:14336
    ds_read_b64_tr_b16 v[62:63], v3 offset:14848
    v_mfma_f32_32x32x16_bf16 v[80:95], v[148:151], v[44:47], v[80:95]
    ds_read_b64_tr_b16 v[32:33], v2 offset:16384
    ds_read_b64_tr_b16 v[34:35], v2 offset:16896
    s_waitcnt lgkmcnt(6)
    v_mfma_f32_32x32x16_bf16 v[64:79], v[152:155], v[48:51], v[64:79]
    ds_read_b64_tr_b16 v[36:37], v3 offset:16384
    ds_read_b64_tr_b16 v[38:39], v3 offset:16896
    v_mfma_f32_32x32x16_bf16 v[80:95], v[152:155], v[52:55], v[80:95]
    ds_read_b64_tr_b16 v[40:41], v2 offset:18432
    ds_read_b64_tr_b16 v[42:43], v2 offset:18944
    s_waitcnt lgkmcnt(6)
    v_mfma_f32_32x32x16_bf16 v[64:79], v[156:159], v[56:59], v[64:79]
    ds_read_b64_tr_b16 v[44:45], v3 offset:18432
    ds_read_b64_tr_b16 v[46:47], v3 offset:18944
    v_mfma_f32_32x32x16_bf16 v[80:95], v[156:159], v[60:63], v[80:95]
    ds_read_b64_tr_b16 v[48:49], v2 offset:20480
    ds_read_b64_tr_b16 v[50:51], v2 offset:20992
    s_waitcnt lgkmcnt(6)
    v_mfma_f32_32x32x16_bf16 v[64:79], v[160:163], v[32:35], v[64:79]
    ds_read_b64_tr_b16 v[52:53], v3 offset:20480
    ds_read_b64_tr_b16 v[54:55], v3 offset:20992
    v_mfma_f32_32x32x16_bf16 v[80:95], v[160:163], v[36:39], v[80:95]
    ds_read_b64_tr_b16 v[56:57], v2 offset:22528
    ds_read_b64_tr_b16 v[58:59], v2 offset:23040
    s_waitcnt lgkmcnt(6)
    v_mfma_f32_32x32x16_bf16 v[64:79], v[164:167], v[40:43], v[64:79]
    ds_read_b64_tr_b16 v[60:61], v3 offset:22528
    ds_read_b64_tr_b16 v[62:63], v3 offset:23040
    v_mfma_f32_32x32x16_bf16 v[80:95], v[164:167], v[44:47], v[80:95]
    ds_read_b64_tr_b16 v[32:33], v2 offset:24576
    ds_read_b64_tr_b16 v[34:35], v2 offset:25088
    s_waitcnt lgkmcnt(6)
    v_mfma_f32_32x32x16_bf16 v[64:79], v[168:171], v[48:51], v[64:79]
    ds_read_b64_tr_b16 v[36:37], v3 offset:24576
    ds_read_b64_tr_b16 v[38:39], v3 offset:25088
    v_mfma_f32_32x32x16_bf16 v[80:95], v[168:171], v[52:55], v[80:95]
    ds_read_b64_tr_b16 v[40:41], v2 offset:26624
    ds_read_b64_tr_b16 v[42:43], v2 offset:27136
    s_waitcnt lgkmcnt(6)
    v_mfma_f32_32x32x16_bf16 v[64:79], v[172:175], v[56:59], v[64:79]
    ds_read_b64_tr_b16 v[44:45], v3 offset:26624
    ds_read_b64_tr_b16 v[46:47], v3 offset:27136
    v_mfma_f32_32x32x16_bf16 v[80:95], v[172:175], v[60:63], v[80:95]
    ds_read_b64_tr_b16 v[48:49], v2 offset:28672
    ds_read_b64_tr_b16 v[50:51], v2 offset:29184
    s_waitcnt lgkmcnt(6)
    v_mfma_f32_32x32x16_bf16 v[64:79], v[176:179], v[32:35], v[64:79]
    ds_read_b64_tr_b16 v[52:53], v3 offset:28672
    ds_read_b64_tr_b16 v[54:55], v3 offset:29184
    v_mfma_f32_32x32x16_bf16 v[80:95], v[176:179], v[36:39], v[80:95]
    ds_read_b64_tr_b16 v[56:57], v2 offset:30720
    ds_read_b64_tr_b16 v[58:59], v2 offset:31232
    s_waitcnt lgkmcnt(6)
    v_mfma_f32_32x32x16_bf16 v[64:79], v[180:183], v[40:43], v[64:79]
    ds_read_b64_tr_b16 v[60:61], v3 offset:30720
    ds_read_b64_tr_b16 v[62:63], v3 offset:31232
    v_mfma_f32_32x32x16_bf16 v[80:95], v[180:183], v[44:47], v[80:95]
    s_add_u32 s49, s49, 0x8000
    s_cmp_eq_u32 s49, 0x28000
    s_cselect_b32 s49, 0x8000, s49
    v_add_u32 v2, s49, v4
    v_add_u32 v3, s49, v5
    ds_read_b64_tr_b16 v[32:33], v2 offset:0
    ds_read_b64_tr_b16 v[34:35], v2 offset:512
    s_waitcnt lgkmcnt(6)
    v_mfma_f32_32x32x16_bf16 v[64:79], v[184:187], v[48:51], v[64:79]
    ds_read_b64_tr_b16 v[36:37], v3 offset:0
    ds_read_b64_tr_b16 v[38:39], v3 offset:512
    v_mfma_f32_32x32x16_bf16 v[80:95], v[184:187], v[52:55], v[80:95]
    ds_read_b64_tr_b16 v[40:41], v2 offset:2048
    ds_read_b64_tr_b16 v[42:43], v2 offset:2560
    s_waitcnt lgkmcnt(6)
    v_mfma_f32_32x32x16_bf16 v[64:79], v[188:191], v[56:59], v[64:79]
    ds_read_b64_tr_b16 v[44:45], v3 offset:2048
    ds_read_b64_tr_b16 v[46:47], v3 offset:2560
    v_mfma_f32_32x32x16_bf16 v[80:95], v[188:191], v[60:63], v[80:95]
    ds_read_b64_tr_b16 v[48:49], v2 offset:4096
    ds_read_b64_tr_b16 v[50:51], v2 offset:4608
    s_waitcnt lgkmcnt(6)
    v_mfma_f32_32x32x16_bf16 v[64:79], v[192:195], v[32:35], v[64:79]
    ds_read_b64_tr_b16 v[52:53], v3 offset:4096
    ds_read_b64_tr_b16 v[54:55], v3 offset:4608
    s_and_b32 s58, s44, 0xff
    v_mfma_f32_32x32x16_bf16 v[80:95], v[192:195], v[36:39], v[80:95]
    s_lshr_b64 s[44:45], s[44:45], 8
    ds_read_b64_tr_b16 v[56:57], v2 offset:6144
    ds_read_b64_tr_b16 v[58:59], v2 offset:6656
    s_waitcnt lgkmcnt(6)
    v_mfma_f32_32x32x16_bf16 v[64:79], v[196:199], v[40:43], v[64:79]
    ds_read_b64_tr_b16 v[60:61], v3 offset:6144
    ds_read_b64_tr_b16 v[62:63], v3 offset:6656
    s_and_b32 s54, s57, 7
    v_mfma_f32_32x32x16_bf16 v[80:95], v[196:199], v[44:47], v[80:95]
    s_lshl_b32 s54, s54, 8
    ds_read_b64_tr_b16 v[32:33], v2 offset:8192
    ds_read_b64_tr_b16 v[34:35], v2 offset:8704
    s_waitcnt lgkmcnt(6)
    v_mfma_f32_32x32x16_bf16 v[64:79], v[200:203], v[48:51], v[64:79]
    ds_read_b64_tr_b16 v[36:37], v3 offset:8192
    ds_read_b64_tr_b16 v[38:39], v3 offset:8704
    s_waitcnt vmcnt(0)
    s_barrier
    v_mfma_f32_32x32x16_bf16 v[80:95], v[200:203], v[52:55], v[80:95]
    s_add_u32 s54, s54, s41
    ds_read_b64_tr_b16 v[40:41], v2 offset:10240
    ds_read_b64_tr_b16 v[42:43], v2 offset:10752
    s_waitcnt lgkmcnt(6)
    v_mfma_f32_32x32x16_bf16 v[64:79], v[204:207], v[56:59], v[64:79]
    ds_read_b64_tr_b16 v[44:45], v3 offset:10240
    ds_read_b64_tr_b16 v[46:47], v3 offset:10752
    s_lshl_b32 s54, s54, 10
    v_mfma_f32_32x32x16_bf16 v[80:95], v[204:207], v[60:63], v[80:95]
    s_add_u32 s66, s54, 0x400000
    ds_read_b64_tr_b16 v[48:49], v2 offset:12288
    ds_read_b64_tr_b16 v[50:51], v2 offset:12800
    s_waitcnt lgkmcnt(6)
    v_mfma_f32_32x32x16_bf16 v[64:79], v[208:211], v[32:35], v[64:79]
    ds_read_b64_tr_b16 v[52:53], v3 offset:12288
    ds_read_b64_tr_b16 v[54:55], v3 offset:12800
    v_mfma_f32_32x32x16_bf16 v[80:95], v[208:211], v[36:39], v[80:95]
    ds_read_b64_tr_b16 v[56:57], v2 offset:14336
    ds_read_b64_tr_b16 v[58:59], v2 offset:14848
    s_waitcnt lgkmcnt(6)
    v_mfma_f32_32x32x16_bf16 v[64:79], v[212:215], v[40:43], v[64:79]
    ds_read_b64_tr_b16 v[60:61], v3 offset:14336
    ds_read_b64_tr_b16 v[62:63], v3 offset:14848
    v_mfma_f32_32x32x16_bf16 v[80:95], v[212:215], v[44:47], v[80:95]
    ds_read_b64_tr_b16 v[32:33], v2 offset:16384
    ds_read_b64_tr_b16 v[34:35], v2 offset:16896
    s_waitcnt lgkmcnt(6)
    v_mfma_f32_32x32x16_bf16 v[64:79], v[216:219], v[48:51], v[64:79]
    ds_read_b64_tr_b16 v[36:37], v3 offset:16384
    ds_read_b64_tr_b16 v[38:39], v3 offset:16896
    v_mfma_f32_32x32x16_bf16 v[80:95], v[216:219], v[52:55], v[80:95]
    ds_read_b64_tr_b16 v[40:41], v2 offset:18432
    ds_read_b64_tr_b16 v[42:43], v2 offset:18944
    s_waitcnt lgkmcnt(6)
    v_mfma_f32_32x32x16_bf16 v[64:79], v[220:223], v[56:59], v[64:79]
    ds_read_b64_tr_b16 v[44:45], v3 offset:18432
    ds_read_b64_tr_b16 v[46:47], v3 offset:18944
    v_mfma_f32_32x32x16_bf16 v[80:95], v[220:223], v[60:63], v[80:95]
    ds_read_b64_tr_b16 v[48:49], v2 offset:20480
    ds_read_b64_tr_b16 v[50:51], v2 offset:20992
    s_waitcnt lgkmcnt(6)
    v_mfma_f32_32x32x16_bf16 v[64:79], v[224:227], v[32:35], v[64:79]
    ds_read_b64_tr_b16 v[52:53], v3 offset:20480
    ds_read_b64_tr_b16 v[54:55], v3 offset:20992
    v_mfma_f32_32x32x16_bf16 v[80:95], v[224:227], v[36:39], v[80:95]
    ds_read_b64_tr_b16 v[56:57], v2 offset:22528
    ds_read_b64_tr_b16 v[58:59], v2 offset:23040
    s_waitcnt lgkmcnt(6)
    v_mfma_f32_32x32x16_bf16 v[64:79], v[228:231], v[40:43], v[64:79]
    ds_read_b64_tr_b16 v[60:61], v3 offset:22528
    ds_read_b64_tr_b16 v[62:63], v3 offset:23040
    v_mfma_f32_32x32x16_bf16 v[80:95], v[228:231], v[44:47], v[80:95]
    ds_read_b64_tr_b16 v[32:33], v2 offset:24576
    ds_read_b64_tr_b16 v[34:35], v2 offset:25088
    s_waitcnt lgkmcnt(6)
    v_mfma_f32_32x32x16_bf16 v[64:79], v[232:235], v[48:51], v[64:79]
    ds_read_b64_tr_b16 v[36:37], v3 offset:24576
    ds_read_b64_tr_b16 v[38:39], v3 offset:25088
    v_mfma_f32_32x32x16_bf16 v[80:95], v[232:235], v[52:55], v[80:95]
    ds_read_b64_tr_b16 v[40:41], v2 offset:26624
    ds_read_b64_tr_b16 v[42:43], v2 offset:27136
    s_waitcnt lgkmcnt(6)
    v_mfma_f32_32x32x16_bf16 v[64:79], v[236:239], v[56:59], v[64:79]
    ds_read_b64_tr_b16 v[44:45], v3 offset:26624
    ds_read_b64_tr_b16 v[46:47], v3 offset:27136
    v_mfma_f32_32x32x16_bf16 v[80:95], v[236:239], v[60:63], v[80:95]
    ds_read_b64_tr_b16 v[48:49], v2 offset:28672
    ds_read_b64_tr_b16 v[50:51], v2 offset:29184
    s_waitcnt lgkmcnt(6)
    v_mfma_f32_32x32x16_bf16 v[64:79], v[240:243], v[32:35], v[64:79]
    ds_read_b64_tr_b16 v[52:53], v3 offset:28672
    ds_read_b64_tr_b16 v[54:55], v3 offset:29184
    v_mfma_f32_32x32x16_bf16 v[80:95], v[240:243], v[36:39], v[80:95]
    ds_read_b64_tr_b16 v[56:57], v2 offset:30720
    ds_read_b64_tr_b16 v[58:59], v2 offset:31232
    s_waitcnt lgkmcnt(6)
    v_mfma_f32_32x32x16_bf16 v[64:79], v[244:247], v[40:43], v[64:79]
    ds_read_b64_tr_b16 v[60:61], v3 offset:30720
    ds_read_b64_tr_b16 v[62:63], v3 offset:31232
    v_mfma_f32_32x32x16_bf16 v[80:95], v[244:247], v[44:47], v[80:95]
    s_add_u32 s49, s49, 0x8000
    s_cmp_eq_u32 s49, 0x28000
    s_cselect_b32 s49, 0x8000, s49
    v_add_u32 v2, s49, v4
    v_add_u32 v3, s49, v5
    ds_read_b64_tr_b16 v[32:33], v2 offset:0
    ds_read_b64_tr_b16 v[34:35], v2 offset:512
    s_waitcnt lgkmcnt(2)
    v_mfma_f32_32x32x16_bf16 v[64:79], v[248:251], v[48:51], v[64:79]
    ds_read_b64_tr_b16 v[36:37], v3 offset:0
    ds_read_b64_tr_b16 v[38:39], v3 offset:512
    v_mfma_f32_32x32x16_bf16 v[64:79], v[252:255], v[56:59], v[64:79]
    ds_read_b64_tr_b16 v[40:41], v2 offset:2048
    ds_read_b64_tr_b16 v[42:43], v2 offset:2560
    v_mfma_f32_32x32x16_bf16 v[80:95], v[248:251], v[52:55], v[80:95]
    ds_read_b64_tr_b16 v[44:45], v3 offset:2048
    ds_read_b64_tr_b16 v[46:47], v3 offset:2560
    v_mfma_f32_32x32x16_bf16 v[80:95], v[252:255], v[60:63], v[80:95]
    v_lshrrev_b32 v112, 5, v1
    v_lshlrev_b32 v112, 4, v112
    ds_bpermute_b32 v96, v112, v12 offset:0
    ds_bpermute_b32 v97, v112, v12 offset:4
    ds_bpermute_b32 v98, v112, v12 offset:8
    ds_bpermute_b32 v99, v112, v12 offset:12
    ds_bpermute_b32 v100, v112, v12 offset:32
    ds_bpermute_b32 v101, v112, v12 offset:36
    ds_bpermute_b32 v102, v112, v12 offset:40
    ds_bpermute_b32 v103, v112, v12 offset:44
    ds_bpermute_b32 v104, v112, v12 offset:64
    ds_bpermute_b32 v105, v112, v12 offset:68
    ds_bpermute_b32 v106, v112, v12 offset:72
    ds_bpermute_b32 v107, v112, v12 offset:76
    ds_bpermute_b32 v108, v112, v12 offset:96
    ds_bpermute_b32 v109, v112, v12 offset:100
    ds_bpermute_b32 v110, v112, v12 offset:104
    ds_bpermute_b32 v111, v112, v12 offset:108
    s_waitcnt lgkmcnt(0)
    v_pk_mul_f32 v[64:65], v[64:65], v[96:97]
    v_pk_mul_f32 v[66:67], v[66:67], v[98:99]
    v_pk_mul_f32 v[68:69], v[68:69], v[100:101]
    v_pk_mul_f32 v[70:71], v[70:71], v[102:103]
    v_cvt_pk_bf16_f32 v16, v64, v65
    v_cvt_pk_bf16_f32 v17, v66, v67
    v_cvt_pk_bf16_f32 v18, v68, v69
    v_cvt_pk_bf16_f32 v19, v70, v71
    buffer_store_dwordx4 v[16:19], v11, s[28:31], s66 offen offset:0 sc1
    v_pk_mul_f32 v[72:73], v[72:73], v[104:105]
    v_pk_mul_f32 v[74:75], v[74:75], v[106:107]
    v_pk_mul_f32 v[76:77], v[76:77], v[108:109]
    v_pk_mul_f32 v[78:79], v[78:79], v[110:111]
    v_cvt_pk_bf16_f32 v20, v72, v73
    v_cvt_pk_bf16_f32 v21, v74, v75
    v_cvt_pk_bf16_f32 v22, v76, v77
    v_cvt_pk_bf16_f32 v23, v78, v79
    buffer_store_dwordx4 v[20:23], v11, s[28:31], s66 offen offset:512 sc1
    s_add_u32 s66, s66, 0x20000
    v_pk_mul_f32 v[80:81], v[80:81], v[96:97]
    v_pk_mul_f32 v[82:83], v[82:83], v[98:99]
    v_pk_mul_f32 v[84:85], v[84:85], v[100:101]
    v_pk_mul_f32 v[86:87], v[86:87], v[102:103]
    v_cvt_pk_bf16_f32 v24, v80, v81
    v_cvt_pk_bf16_f32 v25, v82, v83
    v_cvt_pk_bf16_f32 v26, v84, v85
    v_cvt_pk_bf16_f32 v27, v86, v87
    buffer_store_dwordx4 v[24:27], v11, s[28:31], s66 offen offset:0 sc1
    v_pk_mul_f32 v[88:89], v[88:89], v[104:105]
    v_pk_mul_f32 v[90:91], v[90:91], v[106:107]
    v_pk_mul_f32 v[92:93], v[92:93], v[108:109]
    v_pk_mul_f32 v[94:95], v[94:95], v[110:111]
    v_cvt_pk_bf16_f32 v28, v88, v89
    v_cvt_pk_bf16_f32 v29, v90, v91
    v_cvt_pk_bf16_f32 v30, v92, v93
    v_cvt_pk_bf16_f32 v31, v94, v95
    buffer_store_dwordx4 v[28:31], v11, s[28:31], s66 offen offset:512 sc1
    s_branch L_k1_next
L_k1_chainU:
    ds_read_b64_tr_b16 v[48:49], v2 offset:4096
    ds_read_b64_tr_b16 v[50:51], v2 offset:4608
    s_waitcnt lgkmcnt(6)
    v_mfma_f32_32x32x16_bf16 v[96:111], v[32:35], v[128:131], 0
    ds_read_b64_tr_b16 v[52:53], v3 offset:4096
    ds_read_b64_tr_b16 v[54:55], v3 offset:4608
    v_mfma_f32_32x32x16_bf16 v[112:127], v[36:39], v[128:131], 0
    ds_read_b64_tr_b16 v[56:57], v2 offset:6144
    ds_read_b64_tr_b16 v[58:59], v2 offset:6656
    s_waitcnt lgkmcnt(6)
    v_mfma_f32_32x32x16_bf16 v[96:111], v[40:43], v[132:135], v[96:111]
    ds_read_b64_tr_b16 v[60:61], v3 offset:6144
    ds_read_b64_tr_b16 v[62:63], v3 offset:6656
    v_mfma_f32_32x32x16_bf16 v[112:127], v[44:47], v[132:135], v[112:127]
    ds_read_b64_tr_b16 v[32:33], v2 offset:8192
    ds_read_b64_tr_b16 v[34:35], v2 offset:8704
    s_waitcnt lgkmcnt(6)
    v_mfma_f32_32x32x16_bf16 v[96:111], v[48:51], v[136:139], v[96:111]
    ds_read_b64_tr_b16 v[36:37], v3 offset:8192
    ds_read_b64_tr_b16 v[38:39], v3 offset:8704
    s_barrier
    v_mfma_f32_32x32x16_bf16 v[112:127], v[52:55], v[136:139], v[112:127]
    ds_read_b64_tr_b16 v[40:41], v2 offset:10240
    ds_read_b64_tr_b16 v[42:43], v2 offset:10752
    s_waitcnt lgkmcnt(6)
    v_mfma_f32_32x32x16_bf16 v[96:111], v[56:59], v[140:143], v[96:111]
    ds_read_b64_tr_b16 v[44:45], v3 offset:10240
    ds_read_b64_tr_b16 v[46:47], v3 offset:10752
    v_mfma_f32_32x32x16_bf16 v[112:127], v[60:63], v[140:143], v[112:127]
    ds_read_b64_tr_b16 v[48:49], v2 offset:12288
    ds_read_b64_tr_b16 v[50:51], v2 offset:12800
    s_waitcnt lgkmcnt(6)
    v_mfma_f32_32x32x16_bf16 v[96:111], v[32:35], v[144:147], v[96:111]
    ds_read_b64_tr_b16 v[52:53], v3 offset:12288
    ds_read_b64_tr_b16 v[54:55], v3 offset:12800
    v_mfma_f32_32x32x16_bf16 v[112:127], v[36:39], v[144:147], v[112:127]
    ds_read_b64_tr_b16 v[56:57], v2 offset:14336
    ds_read_b64_tr_b16 v[58:59], v2 offset:14848
    s_waitcnt lgkmcnt(6)
    v_mfma_f32_32x32x16_bf16 v[96:111], v[40:43], v[148:151], v[96:111]
    ds_read_b64_tr_b16 v[60:61], v3 offset:14336
    ds_read_b64_tr_b16 v[62:63], v3 offset:14848
    v_mfma_f32_32x32x16_bf16 v[112:127], v[44:47], v[148:151], v[112:127]
    ds_read_b64_tr_b16 v[32:33], v2 offset:16384
    ds_read_b64_tr_b16 v[34:35], v2 offset:16896
    s_waitcnt lgkmcnt(6)
    v_mfma_f32_32x32x16_bf16 v[96:111], v[48:51], v[152:155], v[96:111]
    ds_read_b64_tr_b16 v[36:37], v3 offset:16384
    ds_read_b64_tr_b16 v[38:39], v3 offset:16896
    v_mfma_f32_32x32x16_bf16 v[112:127], v[52:55], v[152:155], v[112:127]
    ds_read_b64_tr_b16 v[40:41], v2 offset:18432
    ds_read_b64_tr_b16 v[42:43], v2 offset:18944
    s_waitcnt lgkmcnt(6)
    v_mfma_f32_32x32x16_bf16 v[96:111], v[56:59], v[156:159], v[96:111]
    ds_read_b64_tr_b16 v[44:45], v3 offset:18432
    ds_read_b64_tr_b16 v[46:47], v3 offset:18944
    v_mfma_f32_32x32x16_bf16 v[112:127], v[60:63], v[156:159], v[112:127]
    ds_read_b64_tr_b16 v[48:49], v2 offset:20480
    ds_read_b64_tr_b16 v[50:51], v2 offset:20992
    s_waitcnt lgkmcnt(6)
    v_mfma_f32_32x32x16_bf16 v[96:111], v[32:35], v[160:163], v[96:111]
    ds_read_b64_tr_b16 v[52:53], v3 offset:20480
    ds_read_b64_tr_b16 v[54:55], v3 offset:20992
    v_mfma_f32_32x32x16_bf16 v[112:127], v[36:39], v[160:163], v[112:127]
    ds_read_b64_tr_b16 v[56:57], v2 offset:22528
    ds_read_b64_tr_b16 v[58:59], v2 offset:23040
    s_waitcnt lgkmcnt(6)
    v_mfma_f32_32x32x16_bf16 v[96:111], v[40:43], v[164:167], v[96:111]
    ds_read_b64_tr_b16 v[60:61], v3 offset:22528
    ds_read_b64_tr_b16 v[62:63], v3 offset:23040
    v_mfma_f32_32x32x16_bf16 v[112:127], v[44:47], v[164:167], v[112:127]
    ds_read_b64_tr_b16 v[32:33], v2 offset:24576
    ds_read_b64_tr_b16 v[34:35], v2 offset:25088
    s_waitcnt lgkmcnt(6)
    v_mfma_f32_32x32x16_bf16 v[96:111], v[48:51], v[168:171], v[96:111]
    ds_read_b64_tr_b16 v[36:37], v3 offset:24576
    ds_read_b64_tr_b16 v[38:39], v3 offset:25088
    v_mfma_f32_32x32x16_bf16 v[112:127], v[52:55], v[168:171], v[112:127]
    ds_read_b64_tr_b16 v[40:41], v2 offset:26624
    ds_read_b64_tr_b16 v[42:43], v2 offset:27136
    s_waitcnt lgkmcnt(6)
    v_mfma_f32_32x32x16_bf16 v[96:111], v[56:59], v[172:175], v[96:111]
    ds_read_b64_tr_b16 v[44:45], v3 offset:26624
    ds_read_b64_tr_b16 v[46:47], v3 offset:27136
    v_mfma_f32_32x32x16_bf16 v[112:127], v[60:63], v[172:175], v[112:127]
    ds_read_b64_tr_b16 v[48:49], v2 offset:28672
    ds_read_b64_tr_b16 v[50:51], v2 offset:29184
    s_waitcnt lgkmcnt(6)
    v_mfma_f32_32x32x16_bf16 v[96:111], v[32:35], v[176:179], v[96:111]
    ds_read_b64_tr_b16 v[52:53], v3 offset:28672
    ds_read_b64_tr_b16 v[54:55], v3 offset:29184
    v_mfma_f32_32x32x16_bf16 v[112:127], v[36:39], v[176:179], v[112:127]
    ds_read_b64_tr_b16 v[56:57], v2 offset:30720
    ds_read_b64_tr_b16 v[58:59], v2 offset:31232
    s_waitcnt lgkmcnt(6)
    v_mfma_f32_32x32x16_bf16 v[96:111], v[40:43], v[180:183], v[96:111]
    ds_read_b64_tr_b16 v[60:61], v3 offset:30720
    ds_read_b64_tr_b16 v[62:63], v3 offset:31232
    v_mfma_f32_32x32x16_bf16 v[112:127], v[44:47], v[180:183], v[112:127]
    s_add_u32 s49, s49, 0x8000
    s_cmp_eq_u32 s49, 0x28000
    s_cselect_b32 s49, 0x8000, s49
    v_add_u32 v2, s49, v4
    v_add_u32 v3, s49, v5
    ds_read_b64_tr_b16 v[32:33], v2 offset:0
    ds_read_b64_tr_b16 v[34:35], v2 offset:512
    s_waitcnt lgkmcnt(6)
    v_mfma_f32_32x32x16_bf16 v[96:111], v[48:51], v[184:187], v[96:111]
    ds_read_b64_tr_b16 v[36:37], v3 offset:0
    ds_read_b64_tr_b16 v[38:39], v3 offset:512
    v_mfma_f32_32x32x16_bf16 v[112:127], v[52:55], v[184:187], v[112:127]
    ds_read_b64_tr_b16 v[40:41], v2 offset:2048
    ds_read_b64_tr_b16 v[42:43], v2 offset:2560
    s_waitcnt lgkmcnt(6)
    v_mfma_f32_32x32x16_bf16 v[96:111], v[56:59], v[188:191], v[96:111]
    ds_read_b64_tr_b16 v[44:45], v3 offset:2048
    ds_read_b64_tr_b16 v[46:47], v3 offset:2560
    v_mfma_f32_32x32x16_bf16 v[112:127], v[60:63], v[188:191], v[112:127]
    ds_read_b64_tr_b16 v[48:49], v2 offset:4096
    ds_read_b64_tr_b16 v[50:51], v2 offset:4608
    s_waitcnt lgkmcnt(6)
    v_mfma_f32_32x32x16_bf16 v[96:111], v[32:35], v[192:195], v[96:111]
    ds_read_b64_tr_b16 v[52:53], v3 offset:4096
    ds_read_b64_tr_b16 v[54:55], v3 offset:4608
    s_and_b32 s58, s44, 0xff
    v_mfma_f32_32x32x16_bf16 v[112:127], v[36:39], v[192:195], v[112:127]
    s_lshr_b64 s[44:45], s[44:45], 8
    ds_read_b64_tr_b16 v[56:57], v2 offset:6144
    ds_read_b64_tr_b16 v[58:59], v2 offset:6656
    s_waitcnt lgkmcnt(6)
    v_mfma_f32_32x32x16_bf16 v[96:111], v[40:43], v[196:199], v[96:111]
    ds_read_b64_tr_b16 v[60:61], v3 offset:6144
    ds_read_b64_tr_b16 v[62:63], v3 offset:6656
    s_mul_i32 s54, s41, 112
    v_mfma_f32_32x32x16_bf16 v[112:127], v[44:47], v[196:199], v[112:127]
    s_lshl_b32 s53, s57, 2
    ds_read_b64_tr_b16 v[32:33], v2 offset:8192
    ds_read_b64_tr_b16 v[34:35], v2 offset:8704
    s_waitcnt lgkmcnt(6)
    v_mfma_f32_32x32x16_bf16 v[96:111], v[48:51], v[200:203], v[96:111]
    ds_read_b64_tr_b16 v[36:37], v3 offset:8192
    ds_read_b64_tr_b16 v[38:39], v3 offset:8704
    s_waitcnt vmcnt(0)
    s_barrier
    v_mfma_f32_32x32x16_bf16 v[112:127], v[52:55], v[200:203], v[112:127]
    s_add_u32 s54, s54, s53
    ds_read_b64_tr_b16 v[40:41], v2 offset:10240
    ds_read_b64_tr_b16 v[42:43], v2 offset:10752
    s_waitcnt lgkmcnt(6)
    v_mfma_f32_32x32x16_bf16 v[96:111], v[56:59], v[204:207], v[96:111]
    ds_read_b64_tr_b16 v[44:45], v3 offset:10240
    ds_read_b64_tr_b16 v[46:47], v3 offset:10752
    s_lshl_b32 s54, s54, 10
    v_mfma_f32_32x32x16_bf16 v[112:127], v[60:63], v[204:207], v[112:127]
    s_add_u32 s66, s54, 0x800000
    ds_read_b64_tr_b16 v[48:49], v2 offset:12288
    ds_read_b64_tr_b16 v[50:51], v2 offset:12800
    s_waitcnt lgkmcnt(6)
    v_mfma_f32_32x32x16_bf16 v[96:111], v[32:35], v[208:211], v[96:111]
    ds_read_b64_tr_b16 v[52:53], v3 offset:12288
    ds_read_b64_tr_b16 v[54:55], v3 offset:12800
    v_mfma_f32_32x32x16_bf16 v[112:127], v[36:39], v[208:211], v[112:127]
    ds_read_b64_tr_b16 v[56:57], v2 offset:14336
    ds_read_b64_tr_b16 v[58:59], v2 offset:14848
    s_waitcnt lgkmcnt(6)
    v_mfma_f32_32x32x16_bf16 v[96:111], v[40:43], v[212:215], v[96:111]
    ds_read_b64_tr_b16 v[60:61], v3 offset:14336
    ds_read_b64_tr_b16 v[62:63], v3 offset:14848
    v_mfma_f32_32x32x16_bf16 v[112:127], v[44:47], v[212:215], v[112:127]
    ds_read_b64_tr_b16 v[32:33], v2 offset:16384
    ds_read_b64_tr_b16 v[34:35], v2 offset:16896
    s_waitcnt lgkmcnt(6)
    v_mfma_f32_32x32x16_bf16 v[96:111], v[48:51], v[216:219], v[96:111]
    ds_read_b64_tr_b16 v[36:37], v3 offset:16384
    ds_read_b64_tr_b16 v[38:39], v3 offset:16896
    v_mfma_f32_32x32x16_bf16 v[112:127], v[52:55], v[216:219], v[112:127]
    ds_read_b64_tr_b16 v[40:41], v2 offset:18432
    ds_read_b64_tr_b16 v[42:43], v2 offset:18944
    s_waitcnt lgkmcnt(6)
    v_mfma_f32_32x32x16_bf16 v[96:111], v[56:59], v[220:223], v[96:111]
    ds_read_b64_tr_b16 v[44:45], v3 offset:18432
    ds_read_b64_tr_b16 v[46:47], v3 offset:18944
    v_mfma_f32_32x32x16_bf16 v[112:127], v[60:63], v[220:223], v[112:127]
    ds_read_b64_tr_b16 v[48:49], v2 offset:20480
    ds_read_b64_tr_b16 v[50:51], v2 offset:20992
    s_waitcnt lgkmcnt(6)
    v_mfma_f32_32x32x16_bf16 v[96:111], v[32:35], v[224:227], v[96:111]
    ds_read_b64_tr_b16 v[52:53], v3 offset:20480
    ds_read_b64_tr_b16 v[54:55], v3 offset:20992
    v_mfma_f32_32x32x16_bf16 v[112:127], v[36:39], v[224:227], v[112:127]
    ds_read_b64_tr_b16 v[56:57], v2 offset:22528
    ds_read_b64_tr_b16 v[58:59], v2 offset:23040
    s_waitcnt lgkmcnt(6)
    v_mfma_f32_32x32x16_bf16 v[96:111], v[40:43], v[228:231], v[96:111]
    ds_read_b64_tr_b16 v[60:61], v3 offset:22528
    ds_read_b64_tr_b16 v[62:63], v3 offset:23040
    v_mfma_f32_32x32x16_bf16 v[112:127], v[44:47], v[228:231], v[112:127]
    ds_read_b64_tr_b16 v[32:33], v2 offset:24576
    ds_read_b64_tr_b16 v[34:35], v2 offset:25088
    s_waitcnt lgkmcnt(6)
    v_mfma_f32_32x32x16_bf16 v[96:111], v[48:51], v[232:235], v[96:111]
    ds_read_b64_tr_b16 v[36:37], v3 offset:24576
    ds_read_b64_tr_b16 v[38:39], v3 offset:25088
    v_mfma_f32_32x32x16_bf16 v[112:127], v[52:55], v[232:235], v[112:127]
    ds_read_b64_tr_b16 v[40:41], v2 offset:26624
    ds_read_b64_tr_b16 v[42:43], v2 offset:27136
    s_waitcnt lgkmcnt(6)
    v_mfma_f32_32x32x16_bf16 v[96:111], v[56:59], v[236:239], v[96:111]
    ds_read_b64_tr_b16 v[44:45], v3 offset:26624
    ds_read_b64_tr_b16 v[46:47], v3 offset:27136
    v_mfma_f32_32x32x16_bf16 v[112:127], v[60:63], v[236:239], v[112:127]
    ds_read_b64_tr_b16 v[48:49], v2 offset:28672
    ds_read_b64_tr_b16 v[50:51], v2 offset:29184
    s_waitcnt lgkmcnt(6)
    v_mfma_f32_32x32x16_bf16 v[96:111], v[32:35], v[240:243], v[96:111]
    ds_read_b64_tr_b16 v[52:53], v3 offset:28672
    ds_read_b64_tr_b16 v[54:55], v3 offset:29184
    v_mfma_f32_32x32x16_bf16 v[112:127], v[36:39], v[240:243], v[112:127]
    ds_read_b64_tr_b16 v[56:57], v2 offset:30720
    ds_read_b64_tr_b16 v[58:59], v2 offset:31232
    s_waitcnt lgkmcnt(6)
    v_mfma_f32_32x32x16_bf16 v[96:111], v[40:43], v[244:247], v[96:111]
    ds_read_b64_tr_b16 v[60:61], v3 offset:30720
    ds_read_b64_tr_b16 v[62:63], v3 offset:31232
    v_mfma_f32_32x32x16_bf16 v[112:127], v[44:47], v[244:247], v[112:127]
    s_add_u32 s49, s49, 0x8000
    s_cmp_eq_u32 s49, 0x28000
    s_cselect_b32 s49, 0x8000, s49
    v_add_u32 v2, s49, v4
    v_add_u32 v3, s49, v5
    ds_read_b64_tr_b16 v[32:33], v2 offset:0
    ds_read_b64_tr_b16 v[34:35], v2 offset:512
    s_waitcnt lgkmcnt(2)
    v_mfma_f32_32x32x16_bf16 v[96:111], v[48:51], v[248:251], v[96:111]
    ds_read_b64_tr_b16 v[36:37], v3 offset:0
    ds_read_b64_tr_b16 v[38:39], v3 offset:512
    v_mfma_f32_32x32x16_bf16 v[96:111], v[56:59], v[252:255], v[96:111]
    ds_read_b64_tr_b16 v[40:41], v2 offset:2048
    ds_read_b64_tr_b16 v[42:43], v2 offset:2560
    v_mfma_f32_32x32x16_bf16 v[112:127], v[52:55], v[248:251], v[112:127]
    ds_read_b64_tr_b16 v[44:45], v3 offset:2048
    ds_read_b64_tr_b16 v[46:47], v3 offset:2560
    v_mfma_f32_32x32x16_bf16 v[112:127], v[60:63], v[252:255], v[112:127]
    s_nop 5
    v_pk_mul_f32 v[64:65], v[64:65], v[96:97]
    v_pk_mul_f32 v[66:67], v[66:67], v[98:99]
    v_pk_mul_f32 v[68:69], v[68:69], v[100:101]
    v_pk_mul_f32 v[70:71], v[70:71], v[102:103]
    v_pk_mul_f32 v[64:65], v[64:65], v[12:13] op_sel:[0,1] op_sel_hi:[1,1]
    v_pk_mul_f32 v[66:67], v[66:67], v[12:13] op_sel:[0,1] op_sel_hi:[1,1]
    v_pk_mul_f32 v[68:69], v[68:69], v[12:13] op_sel:[0,1] op_sel_hi:[1,1]
    v_pk_mul_f32 v[70:71], v[70:71], v[12:13] op_sel:[0,1] op_sel_hi:[1,1]
    v_cvt_pk_bf16_f32 v16, v64, v65
    v_cvt_pk_bf16_f32 v17, v66, v67
    v_cvt_pk_bf16_f32 v18, v68, v69
    v_cvt_pk_bf16_f32 v19, v70, v71
    buffer_store_dwordx4 v[16:19], v10, s[28:31], s66 offen offset:0 sc1
    v_pk_mul_f32 v[72:73], v[72:73], v[104:105]
    v_pk_mul_f32 v[74:75], v[74:75], v[106:107]
    v_pk_mul_f32 v[76:77], v[76:77], v[108:109]
    v_pk_mul_f32 v[78:79], v[78:79], v[110:111]
    v_pk_mul_f32 v[72:73], v[72:73], v[12:13] op_sel:[0,1] op_sel_hi:[1,1]
    v_pk_mul_f32 v[74:75], v[74:75], v[12:13] op_sel:[0,1] op_sel_hi:[1,1]
    v_pk_mul_f32 v[76:77], v[76:77], v[12:13] op_sel:[0,1] op_sel_hi:[1,1]
    v_pk_mul_f32 v[78:79], v[78:79], v[12:13] op_sel:[0,1] op_sel_hi:[1,1]
    v_cvt_pk_bf16_f32 v20, v72, v73
    v_cvt_pk_bf16_f32 v21, v74, v75
    v_cvt_pk_bf16_f32 v22, v76, v77
    v_cvt_pk_bf16_f32 v23, v78, v79
    buffer_store_dwordx4 v[20:23], v10, s[28:31], s66 offen offset:1024 sc1
    v_pk_mul_f32 v[80:81], v[80:81], v[112:113]
    v_pk_mul_f32 v[82:83], v[82:83], v[114:115]
    v_pk_mul_f32 v[84:85], v[84:85], v[116:117]
    v_pk_mul_f32 v[86:87], v[86:87], v[118:119]
    v_pk_mul_f32 v[80:81], v[80:81], v[12:13] op_sel:[0,1] op_sel_hi:[1,1]
    v_pk_mul_f32 v[82:83], v[82:83], v[12:13] op_sel:[0,1] op_sel_hi:[1,1]
    v_pk_mul_f32 v[84:85], v[84:85], v[12:13] op_sel:[0,1] op_sel_hi:[1,1]
    v_pk_mul_f32 v[86:87], v[86:87], v[12:13] op_sel:[0,1] op_sel_hi:[1,1]
    v_cvt_pk_bf16_f32 v24, v80, v81
    v_cvt_pk_bf16_f32 v25, v82, v83
    v_cvt_pk_bf16_f32 v26, v84, v85
    v_cvt_pk_bf16_f32 v27, v86, v87
    buffer_store_dwordx4 v[24:27], v10, s[28:31], s66 offen offset:2048 sc1
    v_pk_mul_f32 v[88:89], v[88:89], v[120:121]
    v_pk_mul_f32 v[90:91], v[90:91], v[122:123]
    v_pk_mul_f32 v[92:93], v[92:93], v[124:125]
    v_pk_mul_f32 v[94:95], v[94:95], v[126:127]
    v_pk_mul_f32 v[88:89], v[88:89], v[12:13] op_sel:[0,1] op_sel_hi:[1,1]
    v_pk_mul_f32 v[90:91], v[90:91], v[12:13] op_sel:[0,1] op_sel_hi:[1,1]
    v_pk_mul_f32 v[92:93], v[92:93], v[12:13] op_sel:[0,1] op_sel_hi:[1,1]
    v_pk_mul_f32 v[94:95], v[94:95], v[12:13] op_sel:[0,1] op_sel_hi:[1,1]
    v_cvt_pk_bf16_f32 v28, v88, v89
    v_cvt_pk_bf16_f32 v29, v90, v91
    v_cvt_pk_bf16_f32 v30, v92, v93
    v_cvt_pk_bf16_f32 v31, v94, v95
    buffer_store_dwordx4 v[28:31], v10, s[28:31], s66 offen offset:3072 sc1
L_k1_nextG:
L_k1_next:
    s_add_u32 s48, s48, 1
    s_cmp_lt_u32 s48, 5
    s_cbranch_scc1 L_k1_job
    s_and_b32 s53, s2, 31
    s_lshl_b32 s53, s53, 16
    s_and_b32 s54, s40, 1
    s_lshl_b32 s54, s54, 12
    s_add_u32 s54, s54, 8192
    s_add_u32 s53, s53, s54
    s_lshr_b32 s55, s40, 1
    s_lshl_b32 s70, s55, 16
    s_add_u32 s54, s54, s70
    s_mov_b32 m0, s54
    s_lshl_b32 s55, s55, 21
    s_add_u32 s53, s53, s55
    s_add_u32 s70, s53, 0x200000
    s_mov_b32 s54, 7
    s_barrier
L_kf_ld:
    buffer_load_dwordx4 v10, s[28:31], s70 offen offset:0 sc1 lds
    buffer_load_dwordx4 v10, s[28:31], s70 offen offset:1024 sc1 lds
    buffer_load_dwordx4 v10, s[28:31], s70 offen offset:2048 sc1 lds
    buffer_load_dwordx4 v10, s[28:31], s70 offen offset:3072 sc1 lds
    s_addk_i32 m0, 8192
    s_add_u32 s70, s70, 8192
    s_sub_u32 s54, s54, 1
    s_cmp_lg_u32 s54, 0
    s_cbranch_scc1 L_kf_ld
    s_waitcnt vmcnt(0)
    s_barrier
    s_cmp_lg_u32 s40, 0
    s_cbranch_scc1 L_nohsig_3
    s_add_u32 s53, s42, 8
    s_lshl_b32 s53, s53, 7
    s_add_u32 s53, s53, 0x1d00000
    v_mov_b32 v16, 0
    v_mov_b32 v17, 1
    s_mov_b64 exec, 1
    buffer_atomic_add v17, v16, s[28:31], s53 offen sc1
    s_mov_b64 exec, -1
L_nohsig_3:
    s_mov_b32 s6, s4
    s_mov_b32 s7, s5
    s_mov_b32 s4, s16
    s_mov_b32 s5, s17
    s_mov_b32 s8, s4
    s_and_b32 s9, s5, 0xffff
    s_mov_b32 s10, 0x2000000
    s_mov_b32 s11, 0x20000
    s_mov_b32 s12, s6
    s_and_b32 s13, s7, 0xffff
    s_mov_b32 s14, 0x200000
    s_mov_b32 s15, 0x20000
    s_mov_b32 s43, s40
    v_lshlrev_b32 v4, 4, v1
    s_and_b32 s20, s2, 7
    s_lshl_b32 s20, s20, 2
    s_bfe_u32 s21, s2, 0x20003
    s_add_u32 s38, s20, s21
    s_lshr_b32 s39, s2, 5
    s_lshr_b32 s22, s38, 1
    s_lshl_b32 s22, s22, 7
    s_add_u32 s22, s22, 0x1d00400
    v_mov_b32 v96, 0
    s_mov_b32 s20, 0
    s_mov_b64 exec, 1
    s_branch L_pollchk_5
L_poll_4:
    s_sleep 4
L_pollchk_5:
    buffer_load_dword v97, v96, s[8:11], s22 offen sc1
    s_add_u32 s20, s20, 1
    s_waitcnt vmcnt(0)
    v_readfirstlane_b32 s21, v97
    s_cmp_ge_u32 s20, 0x40000
    s_cbranch_scc1 L_polled_6
    s_cmp_ge_u32 s21, 28
    s_cbranch_scc0 L_poll_4
L_polled_6:
    s_mov_b64 exec, -1
    s_lshl_b32 s22, s39, 7
    s_add_u32 s22, s22, 0x1d00c00
    v_mov_b32 v96, 0
    s_mov_b32 s20, 0
    s_mov_b64 exec, 1
    s_branch L_pollchk_8
L_poll_7:
    s_sleep 4
L_pollchk_8:
    buffer_load_dword v97, v96, s[8:11], s22 offen sc1
    s_add_u32 s20, s20, 1
    s_waitcnt vmcnt(0)
    v_readfirstlane_b32 s21, v97
    s_cmp_ge_u32 s20, 0x40000
    s_cbranch_scc1 L_polled_9
    s_cmp_ge_u32 s21, 9
    s_cbranch_scc0 L_poll_7
L_polled_9:
    s_mov_b64 exec, -1
    s_and_b32 s22, s43, 1
    s_lshr_b32 s23, s43, 1
    s_lshl_b32 s20, s38, 1
    s_add_u32 s20, s20, s22
    s_mul_i32 s36, s20, 114688
    s_add_u32 s36, s36, 0x800000
    s_lshl_b32 s21, s39, 1
    s_add_u32 s21, s21, s23
    s_mul_i32 s37, s21, 114688
    s_add_u32 s37, s37, 0x1000000
    s_lshl_b32 s20, s20, 15
    s_lshl_b32 s21, s21, 6
    s_add_u32 s19, s20, s21
    v_and_b32 v5, 31, v1
    v_lshlrev_b32 v5, 10, v5
    v_lshrrev_b32 v6, 5, v1
    v_lshl_add_u32 v5, v6, 3, v5
    s_setprio 2
    buffer_load_dwordx2 v[24:25], v5, s[12:15], s19 offen offset:0
    buffer_load_dwordx2 v[26:27], v5, s[12:15], s19 offen offset:16
    buffer_load_dwordx2 v[28:29], v5, s[12:15], s19 offen offset:32
    buffer_load_dwordx2 v[30:31], v5, s[12:15], s19 offen offset:48
    buffer_load_dwordx4 v[32:35], v4, s[8:11], s36 offen offset:0
    buffer_load_dwordx4 v[36:39], v4, s[8:11], s37 offen offset:0
    buffer_load_dwordx4 v[40:43], v4, s[8:11], s36 offen offset:1024
    buffer_load_dwordx4 v[44:47], v4, s[8:11], s37 offen offset:1024
    buffer_load_dwordx4 v[48:51], v4, s[8:11], s36 offen offset:2048
    buffer_load_dwordx4 v[52:55], v4, s[8:11], s37 offen offset:2048
    buffer_load_dwordx4 v[56:59], v4, s[8:11], s36 offen offset:3072
    buffer_load_dwordx4 v[60:63], v4, s[8:11], s37 offen offset:3072
    s_add_u32 s36, s36, 4096
    s_add_u32 s37, s37, 4096
    buffer_load_dwordx4 v[64:67], v4, s[8:11], s36 offen offset:0
    buffer_load_dwordx4 v[68:71], v4, s[8:11], s37 offen offset:0
    buffer_load_dwordx4 v[72:75], v4, s[8:11], s36 offen offset:1024
    buffer_load_dwordx4 v[76:79], v4, s[8:11], s37 offen offset:1024
    buffer_load_dwordx4 v[80:83], v4, s[8:11], s36 offen offset:2048
    buffer_load_dwordx4 v[84:87], v4, s[8:11], s37 offen offset:2048
    buffer_load_dwordx4 v[88:91], v4, s[8:11], s36 offen offset:3072
    buffer_load_dwordx4 v[92:95], v4, s[8:11], s37 offen offset:3072
    s_add_u32 s36, s36, 4096
    s_add_u32 s37, s37, 4096
    buffer_load_dwordx4 v[96:99], v4, s[8:11], s36 offen offset:0
    buffer_load_dwordx4 v[100:103], v4, s[8:11], s37 offen offset:0
    buffer_load_dwordx4 v[104:107], v4, s[8:11], s36 offen offset:1024
    buffer_load_dwordx4 v[108:111], v4, s[8:11], s37 offen offset:1024
    buffer_load_dwordx4 v[112:115], v4, s[8:11], s36 offen offset:2048
    buffer_load_dwordx4 v[116:119], v4, s[8:11], s37 offen offset:2048
    buffer_load_dwordx4 v[120:123], v4, s[8:11], s36 offen offset:3072
    buffer_load_dwordx4 v[124:127], v4, s[8:11], s37 offen offset:3072
    s_add_u32 s36, s36, 4096
    s_add_u32 s37, s37, 4096
    buffer_load_dwordx4 v[128:131], v4, s[8:11], s36 offen offset:0
    buffer_load_dwordx4 v[132:135], v4, s[8:11], s37 offen offset:0
    buffer_load_dwordx4 v[136:139], v4, s[8:11], s36 offen offset:1024
    buffer_load_dwordx4 v[140:143], v4, s[8:11], s37 offen offset:1024
    buffer_load_dwordx4 v[144:147], v4, s[8:11], s36 offen offset:2048
    buffer_load_dwordx4 v[148:151], v4, s[8:11], s37 offen offset:2048
    buffer_load_dwordx4 v[152:155], v4, s[8:11], s36 offen offset:3072
    buffer_load_dwordx4 v[156:159], v4, s[8:11], s37 offen offset:3072
    s_add_u32 s36, s36, 4096
    s_add_u32 s37, s37, 4096
    v_mov_b32 v8, 0
    v_mov_b32 v9, 0
    v_mov_b32 v10, 0
    v_mov_b32 v11, 0
    v_mov_b32 v12, 0
    v_mov_b32 v13, 0
    v_mov_b32 v14, 0
    v_mov_b32 v15, 0
    v_mov_b32 v16, 0
    v_mov_b32 v17, 0
    v_mov_b32 v18, 0
    v_mov_b32 v19, 0
    v_mov_b32 v20, 0
    v_mov_b32 v21, 0
    v_mov_b32 v22, 0
    v_mov_b32 v23, 0
    s_mov_b32 s26, 7
    s_lshr_b32 s23, s43, 1
    s_lshl_b32 s21, s39, 1
    s_add_u32 s21, s21, s23
    s_lshl_b32 s21, s21, 15
    s_add_u32 s22, s21, 0x1200000
    s_add_u32 s23, s22, 16384
L_kf_g:
    s_cmp_eq_u32 s26, 1
    s_cselect_b32 s36, s22, s36
    s_cselect_b32 s37, s23, s37
    s_waitcnt vmcnt(30)
    v_mfma_f32_32x32x16_bf16 v[8:23], v[36:39], v[32:35], v[8:23]
    buffer_load_dwordx4 v[32:35], v4, s[8:11], s36 offen offset:0
    buffer_load_dwordx4 v[36:39], v4, s[8:11], s37 offen offset:0
    s_waitcnt vmcnt(30)
    v_mfma_f32_32x32x16_bf16 v[8:23], v[44:47], v[40:43], v[8:23]
    buffer_load_dwordx4 v[40:43], v4, s[8:11], s36 offen offset:1024
    buffer_load_dwordx4 v[44:47], v4, s[8:11], s37 offen offset:1024
    s_waitcnt vmcnt(30)
    v_mfma_f32_32x32x16_bf16 v[8:23], v[52:55], v[48:51], v[8:23]
    buffer_load_dwordx4 v[48:51], v4, s[8:11], s36 offen offset:2048
    buffer_load_dwordx4 v[52:55], v4, s[8:11], s37 offen offset:2048
    s_waitcnt vmcnt(30)
    v_mfma_f32_32x32x16_bf16 v[8:23], v[60:63], v[56:59], v[8:23]
    buffer_load_dwordx4 v[56:59], v4, s[8:11], s36 offen offset:3072
    buffer_load_dwordx4 v[60:63], v4, s[8:11], s37 offen offset:3072
    s_add_u32 s36, s36, 4096
    s_add_u32 s37, s37, 4096
    s_waitcnt vmcnt(30)
    v_mfma_f32_32x32x16_bf16 v[8:23], v[68:71], v[64:67], v[8:23]
    buffer_load_dwordx4 v[64:67], v4, s[8:11], s36 offen offset:0
    buffer_load_dwordx4 v[68:71], v4, s[8:11], s37 offen offset:0
    s_waitcnt vmcnt(30)
    v_mfma_f32_32x32x16_bf16 v[8:23], v[76:79], v[72:75], v[8:23]
    buffer_load_dwordx4 v[72:75], v4, s[8:11], s36 offen offset:1024
    buffer_load_dwordx4 v[76:79], v4, s[8:11], s37 offen offset:1024
    s_waitcnt vmcnt(30)
    v_mfma_f32_32x32x16_bf16 v[8:23], v[84:87], v[80:83], v[8:23]
    buffer_load_dwordx4 v[80:83], v4, s[8:11], s36 offen offset:2048
    buffer_load_dwordx4 v[84:87], v4, s[8:11], s37 offen offset:2048
    s_waitcnt vmcnt(30)
    v_mfma_f32_32x32x16_bf16 v[8:23], v[92:95], v[88:91], v[8:23]
    buffer_load_dwordx4 v[88:91], v4, s[8:11], s36 offen offset:3072
    buffer_load_dwordx4 v[92:95], v4, s[8:11], s37 offen offset:3072
    s_add_u32 s36, s36, 4096
    s_add_u32 s37, s37, 4096
    s_waitcnt vmcnt(30)
    v_mfma_f32_32x32x16_bf16 v[8:23], v[100:103], v[96:99], v[8:23]
    buffer_load_dwordx4 v[96:99], v4, s[8:11], s36 offen offset:0
    buffer_load_dwordx4 v[100:103], v4, s[8:11], s37 offen offset:0
    s_waitcnt vmcnt(30)
    v_mfma_f32_32x32x16_bf16 v[8:23], v[108:111], v[104:107], v[8:23]
    buffer_load_dwordx4 v[104:107], v4, s[8:11], s36 offen offset:1024
    buffer_load_dwordx4 v[108:111], v4, s[8:11], s37 offen offset:1024
    s_waitcnt vmcnt(30)
    v_mfma_f32_32x32x16_bf16 v[8:23], v[116:119], v[112:115], v[8:23]
    buffer_load_dwordx4 v[112:115], v4, s[8:11], s36 offen offset:2048
    buffer_load_dwordx4 v[116:119], v4, s[8:11], s37 offen offset:2048
    s_waitcnt vmcnt(30)
    v_mfma_f32_32x32x16_bf16 v[8:23], v[124:127], v[120:123], v[8:23]
    buffer_load_dwordx4 v[120:123], v4, s[8:11], s36 offen offset:3072
    buffer_load_dwordx4 v[124:127], v4, s[8:11], s37 offen offset:3072
    s_add_u32 s36, s36, 4096
    s_add_u32 s37, s37, 4096
    s_waitcnt vmcnt(30)
    v_mfma_f32_32x32x16_bf16 v[8:23], v[132:135], v[128:131], v[8:23]
    buffer_load_dwordx4 v[128:131], v4, s[8:11], s36 offen offset:0
    buffer_load_dwordx4 v[132:135], v4, s[8:11], s37 offen offset:0
    s_waitcnt vmcnt(30)
    v_mfma_f32_32x32x16_bf16 v[8:23], v[140:143], v[136:139], v[8:23]
    buffer_load_dwordx4 v[136:139], v4, s[8:11], s36 offen offset:1024
    buffer_load_dwordx4 v[140:143], v4, s[8:11], s37 offen offset:1024
    s_waitcnt vmcnt(30)
    v_mfma_f32_32x32x16_bf16 v[8:23], v[148:151], v[144:147], v[8:23]
    buffer_load_dwordx4 v[144:147], v4, s[8:11], s36 offen offset:2048
    buffer_load_dwordx4 v[148:151], v4, s[8:11], s37 offen offset:2048
    s_waitcnt vmcnt(30)
    v_mfma_f32_32x32x16_bf16 v[8:23], v[156:159], v[152:155], v[8:23]
    buffer_load_dwordx4 v[152:155], v4, s[8:11], s36 offen offset:3072
    buffer_load_dwordx4 v[156:159], v4, s[8:11], s37 offen offset:3072
    s_add_u32 s36, s36, 4096
    s_add_u32 s37, s37, 4096
    s_sub_u32 s26, s26, 1
    s_cmp_lg_u32 s26, 0
    s_cbranch_scc1 L_kf_g
    s_load_dwordx2 s[44:45], s[0:1], 56
    s_mov_b32 s21, 0xffff0000
    s_nop 7
    v_lshlrev_b32 v6, 16, v24
    v_and_b32 v7, s21, v24
    v_pk_add_f32 v[8:9], v[8:9], v[6:7]
    v_lshlrev_b32 v6, 16, v25
    v_and_b32 v7, s21, v25
    v_pk_add_f32 v[10:11], v[10:11], v[6:7]
    v_lshlrev_b32 v6, 16, v26
    v_and_b32 v7, s21, v26
    v_pk_add_f32 v[12:13], v[12:13], v[6:7]
    v_lshlrev_b32 v6, 16, v27
    v_and_b32 v7, s21, v27
    v_pk_add_f32 v[14:15], v[14:15], v[6:7]
    v_lshlrev_b32 v6, 16, v28
    v_and_b32 v7, s21, v28
    v_pk_add_f32 v[16:17], v[16:17], v[6:7]
    v_lshlrev_b32 v6, 16, v29
    v_and_b32 v7, s21, v29
    v_pk_add_f32 v[18:19], v[18:19], v[6:7]
    v_lshlrev_b32 v6, 16, v30
    v_and_b32 v7, s21, v30
    v_pk_add_f32 v[20:21], v[20:21], v[6:7]
    v_lshlrev_b32 v6, 16, v31
    v_and_b32 v7, s21, v31
    v_pk_add_f32 v[22:23], v[22:23], v[6:7]
    s_and_b32 s22, s43, 1
    s_lshl_b32 s20, s38, 1
    s_add_u32 s20, s20, s22
    s_lshl_b32 s36, s20, 15
    s_add_u32 s36, s36, 0x1400000
    v_and_b32 v5, 31, v1
    v_lshlrev_b32 v5, 10, v5
    v_lshrrev_b32 v6, 5, v1
    v_lshl_add_u32 v5, v6, 4, v5
    s_waitcnt lgkmcnt(0)
    s_mov_b32 s48, s44
    s_and_b32 s49, s45, 0xffff
    s_mov_b32 s50, 0x200000
    s_mov_b32 s51, 0x20000
    s_setprio 0
    s_barrier
    s_cmp_lg_u32 s43, 0
    s_cbranch_scc1 L_noopoll_10
    s_lshl_b32 s22, s38, 7
    s_add_u32 s22, s22, 0x1d01000
    v_mov_b32 v224, 0
    s_mov_b32 s20, 0
    s_mov_b64 exec, 1
    s_branch L_pollchk_12
L_poll_11:
    s_sleep 1
L_pollchk_12:
    buffer_load_dword v225, v224, s[8:11], s22 offen sc1
    s_add_u32 s20, s20, 1
    s_waitcnt vmcnt(0)
    v_readfirstlane_b32 s21, v225
    s_cmp_ge_u32 s20, 0x40000
    s_cbranch_scc1 L_polled_13
    s_cmp_ge_u32 s21, 32
    s_cbranch_scc0 L_poll_11
L_polled_13:
    s_mov_b64 exec, -1
L_noopoll_10:
    s_barrier
    s_lshr_b32 s23, s43, 1
    s_lshl_b32 s23, s23, 14
    s_add_u32 s36, s36, s23
    s_and_b32 s22, s43, 1
    s_lshl_b32 s22, s22, 15
    s_add_u32 m0, s22, s23
    v_add_u32 v7, s22, v4
    buffer_load_dwordx4 v4, s[8:11], s36 offen offset:0 sc1 lds
    buffer_load_dwordx4 v4, s[8:11], s36 offen offset:1024 sc1 lds
    buffer_load_dwordx4 v4, s[8:11], s36 offen offset:2048 sc1 lds
    buffer_load_dwordx4 v4, s[8:11], s36 offen offset:3072 sc1 lds
    s_addk_i32 m0, 4096
    s_add_u32 s36, s36, 4096
    buffer_load_dwordx4 v4, s[8:11], s36 offen offset:0 sc1 lds
    buffer_load_dwordx4 v4, s[8:11], s36 offen offset:1024 sc1 lds
    buffer_load_dwordx4 v4, s[8:11], s36 offen offset:2048 sc1 lds
    buffer_load_dwordx4 v4, s[8:11], s36 offen offset:3072 sc1 lds
    s_addk_i32 m0, 4096
    s_add_u32 s36, s36, 4096
    buffer_load_dwordx4 v4, s[8:11], s36 offen offset:0 sc1 lds
    buffer_load_dwordx4 v4, s[8:11], s36 offen offset:1024 sc1 lds
    buffer_load_dwordx4 v4, s[8:11], s36 offen offset:2048 sc1 lds
    buffer_load_dwordx4 v4, s[8:11], s36 offen offset:3072 sc1 lds
    s_addk_i32 m0, 4096
    s_add_u32 s36, s36, 4096
    buffer_load_dwordx4 v4, s[8:11], s36 offen offset:0 sc1 lds
    buffer_load_dwordx4 v4, s[8:11], s36 offen offset:1024 sc1 lds
    buffer_load_dwordx4 v4, s[8:11], s36 offen offset:2048 sc1 lds
    buffer_load_dwordx4 v4, s[8:11], s36 offen offset:3072 sc1 lds
    s_waitcnt vmcnt(12)
    s_barrier
    ds_read_b128 v[160:163], v7 offset:0
    ds_read_b128 v[164:167], v7 offset:16384
    ds_read_b128 v[168:171], v7 offset:1024
    ds_read_b128 v[172:175], v7 offset:17408
    ds_read_b128 v[176:179], v7 offset:2048
    ds_read_b128 v[180:183], v7 offset:18432
    ds_read_b128 v[184:187], v7 offset:3072
    ds_read_b128 v[188:191], v7 offset:19456
    s_waitcnt lgkmcnt(7)
    v_mfma_f32_32x32x16_bf16 v[8:23], v[32:35], v[160:163], v[8:23]
    s_waitcnt lgkmcnt(6)
    v_mfma_f32_32x32x16_bf16 v[8:23], v[36:39], v[164:167], v[8:23]
    s_waitcnt lgkmcnt(5)
    v_mfma_f32_32x32x16_bf16 v[8:23], v[40:43], v[168:171], v[8:23]
    s_waitcnt lgkmcnt(4)
    v_mfma_f32_32x32x16_bf16 v[8:23], v[44:47], v[172:175], v[8:23]
    s_waitcnt lgkmcnt(3)
    v_mfma_f32_32x32x16_bf16 v[8:23], v[48:51], v[176:179], v[8:23]
    s_waitcnt lgkmcnt(2)
    v_mfma_f32_32x32x16_bf16 v[8:23], v[52:55], v[180:183], v[8:23]
    s_waitcnt lgkmcnt(1)
    v_mfma_f32_32x32x16_bf16 v[8:23], v[56:59], v[184:187], v[8:23]
    s_waitcnt lgkmcnt(0)
    v_mfma_f32_32x32x16_bf16 v[8:23], v[60:63], v[188:191], v[8:23]
    s_waitcnt vmcnt(8)
    s_barrier
    ds_read_b128 v[192:195], v7 offset:4096
    ds_read_b128 v[196:199], v7 offset:20480
    ds_read_b128 v[200:203], v7 offset:5120
    ds_read_b128 v[204:207], v7 offset:21504
    ds_read_b128 v[208:211], v7 offset:6144
    ds_read_b128 v[212:215], v7 offset:22528
    ds_read_b128 v[216:219], v7 offset:7168
    ds_read_b128 v[220:223], v7 offset:23552
    s_waitcnt lgkmcnt(7)
    v_mfma_f32_32x32x16_bf16 v[8:23], v[64:67], v[192:195], v[8:23]
    s_waitcnt lgkmcnt(6)
    v_mfma_f32_32x32x16_bf16 v[8:23], v[68:71], v[196:199], v[8:23]
    s_waitcnt lgkmcnt(5)
    v_mfma_f32_32x32x16_bf16 v[8:23], v[72:75], v[200:203], v[8:23]
    s_waitcnt lgkmcnt(4)
    v_mfma_f32_32x32x16_bf16 v[8:23], v[76:79], v[204:207], v[8:23]
    s_waitcnt lgkmcnt(3)
    v_mfma_f32_32x32x16_bf16 v[8:23], v[80:83], v[208:211], v[8:23]
    s_waitcnt lgkmcnt(2)
    v_mfma_f32_32x32x16_bf16 v[8:23], v[84:87], v[212:215], v[8:23]
    s_waitcnt lgkmcnt(1)
    v_mfma_f32_32x32x16_bf16 v[8:23], v[88:91], v[216:219], v[8:23]
    s_waitcnt lgkmcnt(0)
    v_mfma_f32_32x32x16_bf16 v[8:23], v[92:95], v[220:223], v[8:23]
    s_waitcnt vmcnt(4)
    s_barrier
    ds_read_b128 v[160:163], v7 offset:8192
    ds_read_b128 v[164:167], v7 offset:24576
    ds_read_b128 v[168:171], v7 offset:9216
    ds_read_b128 v[172:175], v7 offset:25600
    ds_read_b128 v[176:179], v7 offset:10240
    ds_read_b128 v[180:183], v7 offset:26624
    ds_read_b128 v[184:187], v7 offset:11264
    ds_read_b128 v[188:191], v7 offset:27648
    s_waitcnt lgkmcnt(7)
    v_mfma_f32_32x32x16_bf16 v[8:23], v[96:99], v[160:163], v[8:23]
    s_waitcnt lgkmcnt(6)
    v_mfma_f32_32x32x16_bf16 v[8:23], v[100:103], v[164:167], v[8:23]
    s_waitcnt lgkmcnt(5)
    v_mfma_f32_32x32x16_bf16 v[8:23], v[104:107], v[168:171], v[8:23]
    s_waitcnt lgkmcnt(4)
    v_mfma_f32_32x32x16_bf16 v[8:23], v[108:111], v[172:175], v[8:23]
    s_waitcnt lgkmcnt(3)
    v_mfma_f32_32x32x16_bf16 v[8:23], v[112:115], v[176:179], v[8:23]
    s_waitcnt lgkmcnt(2)
    v_mfma_f32_32x32x16_bf16 v[8:23], v[116:119], v[180:183], v[8:23]
    s_waitcnt lgkmcnt(1)
    v_mfma_f32_32x32x16_bf16 v[8:23], v[120:123], v[184:187], v[8:23]
    s_waitcnt lgkmcnt(0)
    v_mfma_f32_32x32x16_bf16 v[8:23], v[124:127], v[188:191], v[8:23]
    s_waitcnt vmcnt(0)
    s_barrier
    ds_read_b128 v[192:195], v7 offset:12288
    ds_read_b128 v[196:199], v7 offset:28672
    ds_read_b128 v[200:203], v7 offset:13312
    ds_read_b128 v[204:207], v7 offset:29696
    ds_read_b128 v[208:211], v7 offset:14336
    ds_read_b128 v[212:215], v7 offset:30720
    ds_read_b128 v[216:219], v7 offset:15360
    ds_read_b128 v[220:223], v7 offset:31744
    s_waitcnt lgkmcnt(7)
    v_mfma_f32_32x32x16_bf16 v[8:23], v[128:131], v[192:195], v[8:23]
    s_waitcnt lgkmcnt(6)
    v_mfma_f32_32x32x16_bf16 v[8:23], v[132:135], v[196:199], v[8:23]
    s_waitcnt lgkmcnt(5)
    v_mfma_f32_32x32x16_bf16 v[8:23], v[136:139], v[200:203], v[8:23]
    s_waitcnt lgkmcnt(4)
    v_mfma_f32_32x32x16_bf16 v[8:23], v[140:143], v[204:207], v[8:23]
    s_waitcnt lgkmcnt(3)
    v_mfma_f32_32x32x16_bf16 v[8:23], v[144:147], v[208:211], v[8:23]
    s_waitcnt lgkmcnt(2)
    v_mfma_f32_32x32x16_bf16 v[8:23], v[148:151], v[212:215], v[8:23]
    s_waitcnt lgkmcnt(1)
    v_mfma_f32_32x32x16_bf16 v[8:23], v[152:155], v[216:219], v[8:23]
    s_waitcnt lgkmcnt(0)
    v_mfma_f32_32x32x16_bf16 v[8:23], v[156:159], v[220:223], v[8:23]
    s_nop 11
    v_cvt_pk_bf16_f32 v32, v8, v9
    v_cvt_pk_bf16_f32 v33, v10, v11
    v_cvt_pk_bf16_f32 v34, v12, v13
    v_cvt_pk_bf16_f32 v35, v14, v15
    v_cvt_pk_bf16_f32 v36, v16, v17
    v_cvt_pk_bf16_f32 v37, v18, v19
    v_cvt_pk_bf16_f32 v38, v20, v21
    v_cvt_pk_bf16_f32 v39, v22, v23
    s_nop 1
    v_permlane32_swap_b32 v32, v34
    v_permlane32_swap_b32 v33, v35
    v_permlane32_swap_b32 v36, v38
    v_permlane32_swap_b32 v37, v39
    s_nop 1
    buffer_store_dwordx4 v[32:35], v5, s[48:51], s19 offen offset:0
    buffer_store_dwordx4 v[36:39], v5, s[48:51], s19 offen offset:32
    s_branch L_k1_end
L_k1_loader:
    s_sub_u32 s40, s40, 4
    s_lshl_b32 s41, s42, 2
    s_add_u32 s41, s41, s40
    s_lshl_b32 s51, s40, 13
    v_lshrrev_b32 v16, 3, v1
    v_lshrrev_b32 v17, 4, v1
    v_xor_b32 v17, v17, v1
    v_and_b32 v17, 7, v17
    v_lshlrev_b32 v17, 4, v17
    v_lshl_add_u32 v18, v16, 10, v17
    v_xor_b32 v19, 64, v18
    s_lshl_b32 s68, s41, 15
    s_add_u32 s69, s68, 8192
    s_add_u32 s70, s68, 16384
    s_add_u32 s71, s68, 24576
    s_add_u32 s53, s40, 1
    s_lshl_b32 s53, s53, 15
    s_mov_b32 m0, s53
    s_waitcnt lgkmcnt(0)
    s_mov_b32 s20, s4
    s_and_b32 s21, s5, 0xffff
    s_mov_b32 s22, 0x200000
    s_mov_b32 s23, 0x20000
    s_or_b32 s65, s2, s40
    s_cmp_lg_u32 s65, 0
    s_cbranch_scc1 L_nz_14
    s_mov_b32 s28, s16
    s_and_b32 s29, s17, 0xffff
    s_mov_b32 s30, 0x2000000
    s_mov_b32 s31, 0x20000
    v_lshlrev_b32 v16, 7, v1
    v_mov_b32 v17, 0
    s_mov_b32 s65, 0x1d00000
    buffer_store_dword v17, v16, s[28:31], s65 offen sc1
L_nz_14:
    s_mov_b32 s48, 4
L_k1_xl:
    buffer_load_dwordx4 v18, s[20:23], s68 offen lds
    s_addk_i32 m0, 8192
    s_add_u32 s68, s68, 128
    buffer_load_dwordx4 v19, s[20:23], s69 offen lds
    s_addk_i32 m0, 8192
    s_add_u32 s69, s69, 128
    buffer_load_dwordx4 v18, s[20:23], s70 offen lds
    s_addk_i32 m0, 8192
    s_add_u32 s70, s70, 128
    buffer_load_dwordx4 v19, s[20:23], s71 offen lds
    s_addk_i32 m0, -23552
    s_add_u32 s71, s71, 128
    s_sub_u32 s48, s48, 1
    s_cmp_lg_u32 s48, 0
    s_cbranch_scc1 L_k1_xl
    s_waitcnt vmcnt(8)
    s_barrier
    s_or_b32 s65, s2, s40
    s_cmp_lg_u32 s65, 0
    s_cbranch_scc1 L_nz2_15
    s_load_dwordx2 s[72:73], s[0:1], 64
    s_waitcnt lgkmcnt(0)
    s_mov_b32 s72, s72
    s_and_b32 s73, s73, 0xffff
    s_mov_b32 s74, 0x100
    s_mov_b32 s75, 0x20000
    v_mov_b32 v16, 0
    v_mov_b32 v17, 1
    buffer_store_dword v17, v16, s[72:75], 0 offen sc1
L_nz2_15:
    buffer_load_dwordx4 v18, s[20:23], s68 offen lds
    s_addk_i32 m0, 8192
    s_add_u32 s68, s68, 128
    buffer_load_dwordx4 v19, s[20:23], s69 offen lds
    s_addk_i32 m0, 8192
    s_add_u32 s69, s69, 128
    buffer_load_dwordx4 v18, s[20:23], s70 offen lds
    s_addk_i32 m0, 8192
    s_add_u32 s70, s70, 128
    buffer_load_dwordx4 v19, s[20:23], s71 offen lds
    s_addk_i32 m0, -23552
    s_add_u32 s71, s71, 128
    v_lshrrev_b32 v7, 3, v1
    v_lshrrev_b32 v16, 2, v1
    v_and_b32 v16, 4, v16
    v_and_b32 v17, 7, v1
    v_xor_b32 v16, v16, v17
    v_lshlrev_b32 v8, 4, v16
    s_lshl_b32 s53, s40, 6
    v_add_u32 v7, s53, v7
    s_mov_b32 s27, 0x20000
    buffer_load_dwordx4 v18, s[20:23], s68 offen lds
    s_addk_i32 m0, 8192
    s_add_u32 s68, s68, 128
    buffer_load_dwordx4 v19, s[20:23], s69 offen lds
    s_addk_i32 m0, 8192
    s_add_u32 s69, s69, 128
    buffer_load_dwordx4 v18, s[20:23], s70 offen lds
    s_addk_i32 m0, 8192
    s_add_u32 s70, s70, 128
    buffer_load_dwordx4 v19, s[20:23], s71 offen lds
    s_addk_i32 m0, -23552
    s_add_u32 s71, s71, 128
    s_bfe_u32 s53, s2, 0x20001
    s_lshr_b32 s54, s2, 6
    s_mul_i32 s55, s53, 3
    s_add_u32 s55, s55, s54
    s_add_u32 s43, s55, 11
    s_mul_i32 s55, s53, 3
    s_add_u32 s55, s55, s43
    s_sub_u32 s55, s55, 12
    s_mul_i32 s46, s55, 0x01010100
    s_add_u32 s46, s46, s43
    s_add_u32 s46, s46, 0x23402000
    s_add_u32 s47, s55, 0x806043
    s_cmp_lg_u32 s54, 0
    s_cbranch_scc1 L_kindA_16
    s_mul_i32 s54, s53, 0x01010202
    s_add_u32 s46, s54, 0x38080100
    s_add_u32 s47, s53, 0x806058
L_kindA_16:
    s_mov_b32 s44, s46
    s_mov_b32 s45, s47
    s_waitcnt vmcnt(8)
    s_barrier
    buffer_load_dwordx4 v18, s[20:23], s68 offen lds
    s_addk_i32 m0, 8192
    s_add_u32 s68, s68, 128
    buffer_load_dwordx4 v19, s[20:23], s69 offen lds
    s_addk_i32 m0, 8192
    s_add_u32 s69, s69, 128
    buffer_load_dwordx4 v18, s[20:23], s70 offen lds
    s_addk_i32 m0, 8192
    s_add_u32 s70, s70, 128
    buffer_load_dwordx4 v19, s[20:23], s71 offen lds
    s_addk_i32 m0, -23552
    s_add_u32 s71, s71, 128
    s_sub_u32 s66, 255, s2
    s_and_b32 s53, s66, 7
    s_lshr_b32 s54, s66, 3
    s_mov_b32 s62, 0x80000
    s_mov_b32 s64, 0x1200000
    s_cmp_lt_u32 s66, 56
    s_cselect_b32 s60, s10, s8
    s_cselect_b32 s61, s11, s9
    s_cselect_b32 s62, 0x1c0000, s62
    s_cselect_b32 s55, 0, 7
    s_cselect_b32 s65, 112, 32
    s_cselect_b32 s64, 0x1000000, s64
    s_sub_u32 s54, s54, s55
    s_lshl_b32 s63, s54, 18
    s_lshl_b32 s55, s53, 7
    s_add_u32 s63, s63, s55
    s_lshl_b32 s53, s53, 1
    s_mul_i32 s53, s53, s65
    s_lshl_b32 s54, s54, 4
    s_add_u32 s53, s53, s54
    s_lshl_b32 s54, s40, 2
    s_add_u32 s53, s53, s54
    s_lshl_b32 s53, s53, 10
    s_add_u32 s64, s64, s53
    s_cmp_lt_u32 s66, 72
    s_cselect_b32 s62, s62, 0
    buffer_load_dwordx4 v18, s[20:23], s68 offen lds
    s_addk_i32 m0, 8192
    s_add_u32 s68, s68, 128
    buffer_load_dwordx4 v19, s[20:23], s69 offen lds
    s_addk_i32 m0, 8192
    s_add_u32 s69, s69, 128
    buffer_load_dwordx4 v18, s[20:23], s70 offen lds
    s_addk_i32 m0, 8192
    s_add_u32 s70, s70, 128
    buffer_load_dwordx4 v19, s[20:23], s71 offen lds
    s_addk_i32 m0, -23552
    s_add_u32 s71, s71, 128
    s_and_b32 s52, s46, 0xff
    s_lshr_b64 s[46:47], s[46:47], 8
    s_lshr_b32 s18, s52, 5
    s_and_b32 s19, s52, 31
    s_lshl_b32 s35, s19, 7
    s_cmp_eq_u32 s18, 1
    s_cselect_b32 s32, s12, s6
    s_cselect_b32 s33, s13, s7
    s_cmp_eq_u32 s18, 2
    s_cselect_b32 s32, s14, s32
    s_cselect_b32 s33, s15, s33
    s_movk_i32 s36, 3584
    s_mov_b32 s34, 0x1c0000
    s_cmp_eq_u32 s18, 0
    s_cselect_b32 s34, 0x180000, s34
    s_cselect_b32 s36, 3072, s36
    s_cmp_eq_u32 s18, 3
    s_cselect_b32 s32, s60, s32
    s_cselect_b32 s33, s61, s33
    s_cmp_eq_u32 s18, 3
    s_cselect_b32 s34, s62, s34
    s_cselect_b32 s35, s63, s35
    s_cmp_eq_u32 s18, 3
    s_cselect_b32 s36, 1024, s36
    s_cmp_eq_u32 s18, 4
    s_cselect_b32 s34, 0, s34
    s_mov_b32 s24, s32
    s_and_b32 s25, s33, 0xffff
    s_mov_b32 s26, s34
    s_mov_b32 s38, s35
    s_lshl_b32 s39, s36, 3
    s_mul_i32 s37, s36, 192
    v_mad_u32_u24 v6, v7, s36, v8
    s_waitcnt vmcnt(8)
    s_barrier
    s_mov_b32 s50, 0
    s_add_u32 m0, s50, s51
    s_nop 0
    buffer_load_dwordx4 v6, s[24:27], s38 offen lds
    s_addk_i32 m0, 0x400
    s_add_u32 s38, s38, s39
    buffer_load_dwordx4 v6, s[24:27], s38 offen lds
    s_addk_i32 m0, 0x400
    s_add_u32 s38, s38, s39
    buffer_load_dwordx4 v6, s[24:27], s38 offen lds
    s_addk_i32 m0, 0x400
    s_add_u32 s38, s38, s39
    buffer_load_dwordx4 v6, s[24:27], s38 offen lds
    s_addk_i32 m0, 0x400
    s_add_u32 s38, s38, s39
    buffer_load_dwordx4 v6, s[24:27], s38 offen lds
    s_addk_i32 m0, 0x400
    s_add_u32 s38, s38, s39
    buffer_load_dwordx4 v6, s[24:27], s38 offen lds
    s_addk_i32 m0, 0x400
    s_add_u32 s38, s38, s39
    buffer_load_dwordx4 v6, s[24:27], s38 offen lds
    s_addk_i32 m0, 0x400
    s_add_u32 s38, s38, s39
    buffer_load_dwordx4 v6, s[24:27], s38 offen lds
    s_add_u32 s38, s38, s39
    s_waitcnt vmcnt(8)
    s_barrier
    s_mov_b32 s28, s16
    s_and_b32 s29, s17, 0xffff
    s_mov_b32 s30, 0x2000000
    s_mov_b32 s31, 0x20000
    v_lshrrev_b32 v16, 5, v1
    v_lshlrev_b32 v4, 10, v16
    v_bfe_u32 v16, v1, 2, 2
    v_lshl_add_u32 v4, v16, 7, v4
    v_lshrrev_b32 v16, 1, v16
    v_lshl_add_u32 v4, v16, 6, v4
    v_bfe_u32 v16, v1, 4, 1
    v_lshl_add_u32 v4, v16, 5, v4
    v_and_b32 v16, 3, v1
    v_lshl_add_u32 v4, v16, 3, v4
    v_xor_b32 v5, 64, v4
    v_lshlrev_b32 v10, 4, v1
    s_barrier
    s_mov_b32 s50, 0x20000
    s_add_u32 s38, s38, s37
    s_add_u32 m0, s50, s51
    s_nop 0
    buffer_load_dwordx4 v6, s[24:27], s38 offen lds
    s_addk_i32 m0, 0x400
    s_add_u32 s38, s38, s39
    buffer_load_dwordx4 v6, s[24:27], s38 offen lds
    s_addk_i32 m0, 0x400
    s_add_u32 s38, s38, s39
    buffer_load_dwordx4 v6, s[24:27], s38 offen lds
    s_addk_i32 m0, 0x400
    s_add_u32 s38, s38, s39
    buffer_load_dwordx4 v6, s[24:27], s38 offen lds
    s_addk_i32 m0, 0x400
    s_add_u32 s38, s38, s39
    buffer_load_dwordx4 v6, s[24:27], s38 offen lds
    s_addk_i32 m0, 0x400
    s_add_u32 s38, s38, s39
    buffer_load_dwordx4 v6, s[24:27], s38 offen lds
    s_addk_i32 m0, 0x400
    s_add_u32 s38, s38, s39
    buffer_load_dwordx4 v6, s[24:27], s38 offen lds
    s_addk_i32 m0, 0x400
    s_add_u32 s38, s38, s39
    buffer_load_dwordx4 v6, s[24:27], s38 offen lds
    s_add_u32 s38, s38, s39
    s_and_b32 s52, s46, 0xff
    s_lshr_b64 s[46:47], s[46:47], 8
    s_lshr_b32 s18, s52, 5
    s_and_b32 s19, s52, 31
    s_lshl_b32 s35, s19, 7
    s_cmp_eq_u32 s18, 1
    s_cselect_b32 s32, s12, s6
    s_cselect_b32 s33, s13, s7
    s_cmp_eq_u32 s18, 2
    s_cselect_b32 s32, s14, s32
    s_cselect_b32 s33, s15, s33
    s_movk_i32 s36, 3584
    s_mov_b32 s34, 0x1c0000
    s_cmp_eq_u32 s18, 0
    s_cselect_b32 s34, 0x180000, s34
    s_cselect_b32 s36, 3072, s36
    s_cmp_eq_u32 s18, 3
    s_cselect_b32 s32, s60, s32
    s_cselect_b32 s33, s61, s33
    s_cmp_eq_u32 s18, 3
    s_cselect_b32 s34, s62, s34
    s_cselect_b32 s35, s63, s35
    s_cmp_eq_u32 s18, 3
    s_cselect_b32 s36, 1024, s36
    s_cmp_eq_u32 s18, 4
    s_cselect_b32 s34, 0, s34
    s_mov_b32 s24, s32
    s_and_b32 s25, s33, 0xffff
    s_mov_b32 s26, s34
    s_mov_b32 s38, s35
    s_lshl_b32 s39, s36, 3
    s_mul_i32 s37, s36, 192
    v_mad_u32_u24 v6, v7, s36, v8
    s_mov_b32 s50, 0x8000
    s_add_u32 m0, s50, s51
    s_nop 0
    buffer_load_dwordx4 v6, s[24:27], s38 offen lds
    s_addk_i32 m0, 0x400
    s_add_u32 s38, s38, s39
    buffer_load_dwordx4 v6, s[24:27], s38 offen lds
    s_addk_i32 m0, 0x400
    s_add_u32 s38, s38, s39
    buffer_load_dwordx4 v6, s[24:27], s38 offen lds
    s_addk_i32 m0, 0x400
    s_add_u32 s38, s38, s39
    buffer_load_dwordx4 v6, s[24:27], s38 offen lds
    s_addk_i32 m0, 0x400
    s_add_u32 s38, s38, s39
    buffer_load_dwordx4 v6, s[24:27], s38 offen lds
    s_addk_i32 m0, 0x400
    s_add_u32 s38, s38, s39
    buffer_load_dwordx4 v6, s[24:27], s38 offen lds
    s_addk_i32 m0, 0x400
    s_add_u32 s38, s38, s39
    buffer_load_dwordx4 v6, s[24:27], s38 offen lds
    s_addk_i32 m0, 0x400
    s_add_u32 s38, s38, s39
    buffer_load_dwordx4 v6, s[24:27], s38 offen lds
    s_add_u32 s38, s38, s39
    s_mov_b32 s50, 0x10000
    s_waitcnt vmcnt(16)
    s_barrier
    s_mov_b32 s48, 0
L_k1_ld:
    s_lshl_b32 s53, s48, 2
    s_add_u32 s53, s53, s40
    s_cmp_lg_u32 s53, 4
    s_cbranch_scc1 L_nochk_17
    s_load_dwordx2 s[72:73], s[0:1], 64
    s_waitcnt lgkmcnt(0)
    s_mov_b32 s72, s72
    s_and_b32 s73, s73, 0xffff
    s_mov_b32 s74, 0x100
    s_mov_b32 s75, 0x20000
    v_mov_b32 v24, 0
    s_mov_b32 s53, 0
    s_mov_b64 exec, 1
    s_branch L_pollchk_19
L_poll_18:
    s_sleep 4
L_pollchk_19:
    buffer_load_dword v25, v24, s[72:75], 0 offen sc1
    s_add_u32 s53, s53, 1
    s_waitcnt vmcnt(0)
    v_readfirstlane_b32 s54, v25
    s_cmp_ge_u32 s53, 0x40000
    s_cbranch_scc1 L_polled_20
    s_cmp_ge_u32 s54, 1
    s_cbranch_scc0 L_poll_18
L_polled_20:
    s_mov_b64 exec, -1
L_nochk_17:
    s_waitcnt vmcnt(8)
    s_barrier
    s_add_u32 s38, s38, s37
    s_add_u32 m0, s50, s51
    s_nop 0
    buffer_load_dwordx4 v6, s[24:27], s38 offen lds
    s_addk_i32 m0, 0x400
    s_add_u32 s38, s38, s39
    buffer_load_dwordx4 v6, s[24:27], s38 offen lds
    s_addk_i32 m0, 0x400
    s_add_u32 s38, s38, s39
    buffer_load_dwordx4 v6, s[24:27], s38 offen lds
    s_addk_i32 m0, 0x400
    s_add_u32 s38, s38, s39
    buffer_load_dwordx4 v6, s[24:27], s38 offen lds
    s_addk_i32 m0, 0x400
    s_add_u32 s38, s38, s39
    buffer_load_dwordx4 v6, s[24:27], s38 offen lds
    s_addk_i32 m0, 0x400
    s_add_u32 s38, s38, s39
    buffer_load_dwordx4 v6, s[24:27], s38 offen lds
    s_addk_i32 m0, 0x400
    s_add_u32 s38, s38, s39
    buffer_load_dwordx4 v6, s[24:27], s38 offen lds
    s_addk_i32 m0, 0x400
    s_add_u32 s38, s38, s39
    buffer_load_dwordx4 v6, s[24:27], s38 offen lds
    s_add_u32 s38, s38, s39
    s_add_u32 s50, s50, 0x8000
    s_cmp_eq_u32 s50, 0x28000
    s_cselect_b32 s50, 0x8000, s50
    s_and_b32 s52, s46, 0xff
    s_lshr_b64 s[46:47], s[46:47], 8
    s_lshr_b32 s18, s52, 5
    s_and_b32 s19, s52, 31
    s_lshl_b32 s35, s19, 7
    s_cmp_eq_u32 s18, 1
    s_cselect_b32 s32, s12, s6
    s_cselect_b32 s33, s13, s7
    s_cmp_eq_u32 s18, 2
    s_cselect_b32 s32, s14, s32
    s_cselect_b32 s33, s15, s33
    s_movk_i32 s36, 3584
    s_mov_b32 s34, 0x1c0000
    s_cmp_eq_u32 s18, 0
    s_cselect_b32 s34, 0x180000, s34
    s_cselect_b32 s36, 3072, s36
    s_cmp_eq_u32 s18, 3
    s_cselect_b32 s32, s60, s32
    s_cselect_b32 s33, s61, s33
    s_cmp_eq_u32 s18, 3
    s_cselect_b32 s34, s62, s34
    s_cselect_b32 s35, s63, s35
    s_cmp_eq_u32 s18, 3
    s_cselect_b32 s36, 1024, s36
    s_cmp_eq_u32 s18, 4
    s_cselect_b32 s34, 0, s34
    s_mov_b32 s24, s32
    s_and_b32 s25, s33, 0xffff
    s_mov_b32 s26, s34
    s_mov_b32 s38, s35
    s_lshl_b32 s39, s36, 3
    s_mul_i32 s37, s36, 192
    v_mad_u32_u24 v6, v7, s36, v8
    s_waitcnt vmcnt(8)
    s_barrier
    s_add_u32 m0, s50, s51
    s_nop 0
    buffer_load_dwordx4 v6, s[24:27], s38 offen lds
    s_addk_i32 m0, 0x400
    s_add_u32 s38, s38, s39
    buffer_load_dwordx4 v6, s[24:27], s38 offen lds
    s_addk_i32 m0, 0x400
    s_add_u32 s38, s38, s39
    buffer_load_dwordx4 v6, s[24:27], s38 offen lds
    s_addk_i32 m0, 0x400
    s_add_u32 s38, s38, s39
    buffer_load_dwordx4 v6, s[24:27], s38 offen lds
    s_addk_i32 m0, 0x400
    s_add_u32 s38, s38, s39
    buffer_load_dwordx4 v6, s[24:27], s38 offen lds
    s_addk_i32 m0, 0x400
    s_add_u32 s38, s38, s39
    buffer_load_dwordx4 v6, s[24:27], s38 offen lds
    s_addk_i32 m0, 0x400
    s_add_u32 s38, s38, s39
    buffer_load_dwordx4 v6, s[24:27], s38 offen lds
    s_addk_i32 m0, 0x400
    s_add_u32 s38, s38, s39
    buffer_load_dwordx4 v6, s[24:27], s38 offen lds
    s_add_u32 s38, s38, s39
    s_add_u32 s50, s50, 0x8000
    s_cmp_eq_u32 s50, 0x28000
    s_cselect_b32 s50, 0x8000, s50
    s_cmp_eq_u32 s48, 0
    s_cbranch_scc1 L_nosig_21
    s_and_b32 s52, s44, 0xff
    s_lshr_b64 s[44:45], s[44:45], 8
    s_cmp_lg_u32 s40, 0
    s_cbranch_scc1 L_nosig_21
    s_lshr_b32 s54, s52, 5
    s_cmp_eq_u32 s54, 1
    s_cbranch_scc1 L_nosig_21
    s_and_b32 s53, s52, 7
    s_add_u32 s55, s42, 8
    s_cmp_eq_u32 s54, 2
    s_cselect_b32 s53, s55, s53
    s_lshl_b32 s53, s53, 7
    s_add_u32 s53, s53, 0x1d00000
    v_mov_b32 v24, 0
    v_mov_b32 v25, 1
    s_mov_b64 exec, 1
    buffer_atomic_add v25, v24, s[28:31], s53 offen sc1
    s_mov_b64 exec, -1
L_nosig_21:
    s_add_u32 s48, s48, 1
    s_cmp_lt_u32 s48, 4
    s_cbranch_scc1 L_k1_ld
    s_waitcnt vmcnt(8)
    s_barrier
    s_and_b32 s70, s2, 31
    s_cmp_lg_u32 s40, 0
    s_cbranch_scc1 L_nopoll_22
    s_lshr_b32 s55, s70, 2
    s_lshl_b32 s55, s55, 7
    s_add_u32 s55, s55, 0x1d00000
    v_mov_b32 v24, 0
    s_mov_b32 s53, 0
    s_mov_b64 exec, 1
    s_branch L_pollchk_24
L_poll_23:
    s_sleep 4
L_pollchk_24:
    buffer_load_dword v25, v24, s[28:31], s55 offen sc1
    s_add_u32 s53, s53, 1
    s_waitcnt vmcnt(0)
    v_readfirstlane_b32 s54, v25
    s_cmp_ge_u32 s53, 0x40000
    s_cbranch_scc1 L_polled_25
    s_cmp_ge_u32 s54, 48
    s_cbranch_scc0 L_poll_23
L_polled_25:
    s_mov_b64 exec, -1
L_nopoll_22:
    s_waitcnt vmcnt(8)
    s_barrier
    s_lshr_b32 s54, s70, 2
    s_lshl_b32 s54, s54, 13
    s_add_u32 s54, s54, 0x1c00000
    v_lshlrev_b32 v152, 7, v1
    buffer_load_dword v153, v152, s[28:31], s54 offen sc1
    s_lshr_b32 s55, s2, 5
    s_lshl_b32 s55, s55, 3
    s_lshl_b32 s54, s40, 1
    s_add_u32 s55, s55, s54
    s_lshl_b32 s55, s55, 10
    s_lshl_b32 s70, s70, 16
    s_add_u32 s55, s55, s70
    buffer_load_dwordx4 v[144:147], v10, s[28:31], s55 offen sc1
    buffer_load_dwordx4 v[148:151], v10, s[28:31], s55 offen offset:1024 sc1
    s_lshl_b32 s53, s40, 10
    s_add_u32 s71, s70, s53
    s_add_u32 s54, s71, 0x200000
    s_add_u32 s55, s71, 0x400000
    s_mov_b32 m0, s53
    s_nop 0
    buffer_load_dwordx4 v10, s[28:31], s54 offen sc1 lds
    s_addk_i32 m0, 4096
    s_add_u32 s54, s54, 4096
    buffer_load_dwordx4 v10, s[28:31], s54 offen sc1 lds
    s_add_u32 m0, m0, 61440
    s_nop 0
    buffer_load_dwordx4 v10, s[28:31], s55 offen sc1 lds
    s_addk_i32 m0, 4096
    s_add_u32 s55, s55, 4096
    buffer_load_dwordx4 v10, s[28:31], s55 offen sc1 lds
    s_cmp_ge_u32 s66, 72
    s_cbranch_scc1 L_norel_26
    v_lshrrev_b32 v16, 5, v1
    v_lshlrev_b32 v16, 9, v16
    v_sub_u32 v16, v4, v16
    s_add_u32 s53, s51, 0x8000
    v_add_u32 v16, s53, v16
    v_xor_b32 v17, 64, v16
    s_waitcnt vmcnt(7)
    ds_read_b64_tr_b16 v[32:33], v16 offset:0
    ds_read_b64_tr_b16 v[34:35], v16 offset:1024
    ds_read_b64_tr_b16 v[36:37], v17 offset:0
    ds_read_b64_tr_b16 v[38:39], v17 offset:1024
    ds_read_b64_tr_b16 v[40:41], v16 offset:2048
    ds_read_b64_tr_b16 v[42:43], v16 offset:3072
    ds_read_b64_tr_b16 v[44:45], v17 offset:2048
    ds_read_b64_tr_b16 v[46:47], v17 offset:3072
    ds_read_b64_tr_b16 v[48:49], v16 offset:4096
    ds_read_b64_tr_b16 v[50:51], v16 offset:5120
    ds_read_b64_tr_b16 v[52:53], v17 offset:4096
    ds_read_b64_tr_b16 v[54:55], v17 offset:5120
    ds_read_b64_tr_b16 v[56:57], v16 offset:6144
    ds_read_b64_tr_b16 v[58:59], v16 offset:7168
    ds_read_b64_tr_b16 v[60:61], v17 offset:6144
    ds_read_b64_tr_b16 v[62:63], v17 offset:7168
    s_lshl_b32 s54, s65, 10
    s_add_u32 s54, s54, s64
    s_waitcnt lgkmcnt(0)
    buffer_store_dwordx4 v[32:35], v10, s[28:31], s64 offen offset:0 sc1
    buffer_store_dwordx4 v[36:39], v10, s[28:31], s54 offen offset:0 sc1
    buffer_store_dwordx4 v[40:43], v10, s[28:31], s64 offen offset:1024 sc1
    buffer_store_dwordx4 v[44:47], v10, s[28:31], s54 offen offset:1024 sc1
    buffer_store_dwordx4 v[48:51], v10, s[28:31], s64 offen offset:2048 sc1
    buffer_store_dwordx4 v[52:55], v10, s[28:31], s54 offen offset:2048 sc1
    buffer_store_dwordx4 v[56:59], v10, s[28:31], s64 offen offset:3072 sc1
    buffer_store_dwordx4 v[60:63], v10, s[28:31], s54 offen offset:3072 sc1
L_norel_26:
    s_mov_b32 s4, s16
    s_mov_b32 s5, s17
    s_mov_b32 s8, s4
    s_and_b32 s9, s5, 0xffff
    s_mov_b32 s10, 0x2000000
    s_mov_b32 s11, 0x20000
    s_mov_b32 s34, s40
    s_and_b32 s17, s2, 31
    s_lshr_b32 s18, s2, 5
    v_mov_b32 v4, v10
    v_mov_b32 v2, v10
    v_lshrrev_b32 v154, 5, v1
    v_lshlrev_b32 v3, 8, v154
    v_and_b32 v154, 15, v1
    v_lshl_add_u32 v3, v154, 4, v3
    v_add_u32 v3, 0x10000, v3
    s_mov_b32 s24, 0xffff
    s_mov_b32 s25, 0xffff
    v_and_b32 v155, 27, v1
    v_cmp_eq_u32 vcc, 16, v155
    v_mov_b32 v155, 0x3f803f80
    s_nop 0
    v_cndmask_b32 v154, 0, v155, vcc
    v_mov_b32 v128, v154
    v_mov_b32 v129, v154
    v_mov_b32 v130, v154
    v_mov_b32 v131, v154
    v_mov_b32 v132, v154
    v_mov_b32 v133, v154
    v_mov_b32 v134, v154
    v_mov_b32 v135, v154
    v_mov_b32 v136, v154
    v_mov_b32 v137, v154
    v_mov_b32 v138, v154
    v_mov_b32 v139, v154
    v_mov_b32 v140, v154
    v_mov_b32 v141, v154
    v_mov_b32 v142, v154
    v_mov_b32 v143, v154
    v_mov_b32 v56, 0
    v_mov_b32 v57, 0
    v_mov_b32 v58, 0
    v_mov_b32 v59, 0
    v_mov_b32 v60, 0
    v_mov_b32 v61, 0
    v_mov_b32 v62, 0
    v_mov_b32 v63, 0
    v_mov_b32 v64, 0
    v_mov_b32 v65, 0
    v_mov_b32 v66, 0
    v_mov_b32 v67, 0
    v_mov_b32 v68, 0
    v_mov_b32 v69, 0
    v_mov_b32 v70, 0
    v_mov_b32 v71, 0
    v_mov_b32 v72, 0
    v_mov_b32 v73, 0
    v_mov_b32 v74, 0
    v_mov_b32 v75, 0
    v_mov_b32 v76, 0
    v_mov_b32 v77, 0
    v_mov_b32 v78, 0
    v_mov_b32 v79, 0
    v_mov_b32 v80, 0
    v_mov_b32 v81, 0
    v_mov_b32 v82, 0
    v_mov_b32 v83, 0
    v_mov_b32 v84, 0
    v_mov_b32 v85, 0
    v_mov_b32 v86, 0
    v_mov_b32 v87, 0
    s_cmp_lt_u32 s66, 72
    s_cbranch_scc1 L_wr_27
    s_waitcnt vmcnt(4)
    s_branch L_wd_28
L_wr_27:
    s_waitcnt vmcnt(12)
L_wd_28:
    v_mov_b32 v154, 0
    v_mov_b32 v155, 0
    v_dot2c_f32_bf16 v154, v144, v144
    v_dot2c_f32_bf16 v155, v148, v148
    v_dot2c_f32_bf16 v154, v145, v145
    v_dot2c_f32_bf16 v155, v149, v149
    v_dot2c_f32_bf16 v154, v146, v146
    v_dot2c_f32_bf16 v155, v150, v150
    v_dot2c_f32_bf16 v154, v147, v147
    v_dot2c_f32_bf16 v155, v151, v151
    s_nop 2
    v_mov_b32 v156, v154
    v_mov_b32 v157, v155
    s_nop 0
    v_permlane32_swap_b32 v154, v156
    v_permlane32_swap_b32 v155, v157
    s_nop 0
    v_add_f32 v154, v154, v156
    v_add_f32 v155, v155, v157
    s_nop 0
    v_max_f32 v154, v154, v155
    s_nop 1
    v_max_f32_dpp v153, v153, v153 row_ror:1 row_mask:0xf bank_mask:0xf
    v_max_f32_dpp v154, v154, v154 row_ror:1 row_mask:0xf bank_mask:0xf
    s_nop 0
    v_max_f32_dpp v153, v153, v153 row_ror:2 row_mask:0xf bank_mask:0xf
    v_max_f32_dpp v154, v154, v154 row_ror:2 row_mask:0xf bank_mask:0xf
    s_nop 0
    v_max_f32_dpp v153, v153, v153 row_ror:4 row_mask:0xf bank_mask:0xf
    v_max_f32_dpp v154, v154, v154 row_ror:4 row_mask:0xf bank_mask:0xf
    s_nop 0
    v_max_f32_dpp v153, v153, v153 row_ror:8 row_mask:0xf bank_mask:0xf
    v_max_f32_dpp v154, v154, v154 row_ror:8 row_mask:0xf bank_mask:0xf
    s_nop 0
    v_mov_b32 v156, v153
    v_mov_b32 v157, v154
    s_nop 0
    v_permlane16_swap_b32 v153, v156
    v_permlane16_swap_b32 v154, v157
    s_nop 0
    v_max_f32 v153, v153, v156
    v_max_f32 v154, v154, v157
    s_nop 0
    v_mov_b32 v156, v153
    v_mov_b32 v157, v154
    s_nop 0
    v_permlane32_swap_b32 v153, v156
    v_permlane32_swap_b32 v154, v157
    s_nop 0
    v_max_f32 v153, v153, v156
    v_max_f32 v154, v154, v157
    s_nop 0
    v_mul_f32 v153, v153, v154
    v_sqrt_f32 v153, v153
    s_nop 0
    v_mul_f32 v153, 0x3f828f5c, v153
    s_nop 0
    v_readfirstlane_b32 s27, v153
    v_sub_f32 v153, 0, v153
    v_mov_b32 v88, v153
    v_mov_b32 v104, v153
    v_mov_b32 v89, v153
    v_mov_b32 v105, v153
    v_mov_b32 v90, v153
    v_mov_b32 v106, v153
    v_mov_b32 v91, v153
    v_mov_b32 v107, v153
    v_mov_b32 v92, v153
    v_mov_b32 v108, v153
    v_mov_b32 v93, v153
    v_mov_b32 v109, v153
    v_mov_b32 v94, v153
    v_mov_b32 v110, v153
    v_mov_b32 v95, v153
    v_mov_b32 v111, v153
    v_mov_b32 v96, v153
    v_mov_b32 v112, v153
    v_mov_b32 v97, v153
    v_mov_b32 v113, v153
    v_mov_b32 v98, v153
    v_mov_b32 v114, v153
    v_mov_b32 v99, v153
    v_mov_b32 v115, v153
    v_mov_b32 v100, v153
    v_mov_b32 v116, v153
    v_mov_b32 v101, v153
    v_mov_b32 v117, v153
    v_mov_b32 v102, v153
    v_mov_b32 v118, v153
    v_mov_b32 v103, v153
    v_mov_b32 v119, v153
    s_cmp_lt_u32 s66, 72
    s_cbranch_scc1 L_wr_29
    s_waitcnt vmcnt(0)
    s_branch L_wd_30
L_wr_29:
    s_waitcnt vmcnt(8)
L_wd_30:
    s_barrier
    s_mov_b32 s28, 0
    s_cmp_le_u32 s27, 0x42400000
    s_cbranch_scc1 L_kf_main
    s_waitcnt vmcnt(0)
    s_barrier
    s_cmp_ge_u32 s66, 72
    s_cbranch_scc1 L_norsig_31
    s_cmp_lg_u32 s34, 0
    s_cbranch_scc1 L_norsig_31
    s_and_b32 s20, s66, 7
    s_lshl_b32 s20, s20, 7
    s_add_u32 s20, s20, 0x1d00c00
    v_mov_b32 v154, 0
    v_mov_b32 v155, 1
    s_mov_b64 exec, 1
    buffer_atomic_add v155, v154, s[8:11], s20 offen sc1
    s_mov_b64 exec, -1
L_norsig_31:
    s_mov_b32 s28, 99
    v_mov_b32 v154, 0xff800000
    v_mov_b32 v155, 0xff800000
    v_mov_b32 v156, v4
    s_mov_b32 s26, 64
L_kf_pre:
    ds_read_b128 v[40:43], v156
    v_add_u32 v156, 1024, v156
    s_waitcnt lgkmcnt(0)
    v_mfma_f32_32x32x16_bf16 v[8:23], v[40:43], v[144:147], 0
    v_mfma_f32_32x32x16_bf16 v[24:39], v[40:43], v[148:151], 0
    s_nop 13
    v_max3_f32 v154, v154, v8, v9
    v_max3_f32 v154, v154, v10, v11
    v_max3_f32 v154, v154, v12, v13
    v_max3_f32 v154, v154, v14, v15
    v_max3_f32 v154, v154, v16, v17
    v_max3_f32 v154, v154, v18, v19
    v_max3_f32 v154, v154, v20, v21
    v_max3_f32 v154, v154, v22, v23
    v_max3_f32 v155, v155, v24, v25
    v_max3_f32 v155, v155, v26, v27
    v_max3_f32 v155, v155, v28, v29
    v_max3_f32 v155, v155, v30, v31
    v_max3_f32 v155, v155, v32, v33
    v_max3_f32 v155, v155, v34, v35
    v_max3_f32 v155, v155, v36, v37
    v_max3_f32 v155, v155, v38, v39
    s_sub_u32 s26, s26, 1
    s_cmp_lg_u32 s26, 0
    s_cbranch_scc1 L_kf_pre
    v_mov_b32 v156, v154
    v_mov_b32 v157, v155
    s_nop 1
    v_permlane32_swap_b32 v154, v156
    v_permlane32_swap_b32 v155, v157
    s_nop 1
    v_max_f32 v154, v154, v156
    v_max_f32 v155, v155, v157
    v_sub_f32 v154, 0, v154
    v_sub_f32 v155, 0, v155
    v_mov_b32 v88, v154
    v_mov_b32 v104, v155
    v_mov_b32 v89, v154
    v_mov_b32 v105, v155
    v_mov_b32 v90, v154
    v_mov_b32 v106, v155
    v_mov_b32 v91, v154
    v_mov_b32 v107, v155
    v_mov_b32 v92, v154
    v_mov_b32 v108, v155
    v_mov_b32 v93, v154
    v_mov_b32 v109, v155
    v_mov_b32 v94, v154
    v_mov_b32 v110, v155
    v_mov_b32 v95, v154
    v_mov_b32 v111, v155
    v_mov_b32 v96, v154
    v_mov_b32 v112, v155
    v_mov_b32 v97, v154
    v_mov_b32 v113, v155
    v_mov_b32 v98, v154
    v_mov_b32 v114, v155
    v_mov_b32 v99, v154
    v_mov_b32 v115, v155
    v_mov_b32 v100, v154
    v_mov_b32 v116, v155
    v_mov_b32 v101, v154
    v_mov_b32 v117, v155
    v_mov_b32 v102, v154
    v_mov_b32 v118, v155
    v_mov_b32 v103, v154
    v_mov_b32 v119, v155
L_kf_main:
    ds_read_b128 v[120:123], v2 offset:0
    v_mov_b32 v48, 0
    v_mov_b32 v49, 0
    v_mov_b32 v50, 0
    v_mov_b32 v51, 0
    v_mov_b32 v52, 0
    v_mov_b32 v53, 0
    v_mov_b32 v54, 0
    v_mov_b32 v55, 0
    s_waitcnt lgkmcnt(0)
    v_mfma_f32_32x32x16_bf16 v[8:23], v[120:123], v[144:147], v[88:103]
    s_nop 9
    s_mov_b32 s26, 0
    .p2align 6
L_kf_loop:
    v_mfma_f32_32x32x16_bf16 v[24:39], v[120:123], v[148:151], v[104:119]
    ds_read_b128 v[124:127], v2 offset:1024
    v_exp_f32 v8, v8
    v_exp_f32 v9, v9
    v_exp_f32 v10, v10
    v_exp_f32 v11, v11
    v_exp_f32 v12, v12
    v_mfma_f32_32x32x16_bf16 v[72:87], v[136:139], v[48:51], v[72:87]
    s_mov_b64 exec, s[24:25]
    ds_read_b128 v[128:131], v3 offset:0
    ds_read_b128 v[132:135], v3 offset:512
    s_mov_b64 exec, -1
    v_exp_f32 v13, v13
    v_exp_f32 v14, v14
    v_exp_f32 v15, v15
    v_cvt_pk_bf16_f32 v40, v8, v9
    v_cvt_pk_bf16_f32 v41, v10, v11
    v_exp_f32 v16, v16
    v_exp_f32 v17, v17
    v_mfma_f32_32x32x16_bf16 v[72:87], v[140:143], v[52:55], v[72:87]
    v_cvt_pk_bf16_f32 v42, v12, v13
    v_cvt_pk_bf16_f32 v43, v14, v15
    v_exp_f32 v18, v18
    v_exp_f32 v19, v19
    v_exp_f32 v20, v20
    v_exp_f32 v21, v21
    v_cvt_pk_bf16_f32 v44, v16, v17
    v_exp_f32 v22, v22
    v_exp_f32 v23, v23
    v_cvt_pk_bf16_f32 v45, v18, v19
    v_cvt_pk_bf16_f32 v46, v20, v21
    v_cvt_pk_bf16_f32 v47, v22, v23
    s_waitcnt lgkmcnt(0)
    v_mfma_f32_32x32x16_bf16 v[8:23], v[124:127], v[144:147], v[88:103]
    v_exp_f32 v24, v24
    v_exp_f32 v25, v25
    v_exp_f32 v26, v26
    v_exp_f32 v27, v27
    v_exp_f32 v28, v28
    v_mfma_f32_32x32x16_bf16 v[56:71], v[128:131], v[40:43], v[56:71]
    v_exp_f32 v29, v29
    v_exp_f32 v30, v30
    v_exp_f32 v31, v31
    v_cvt_pk_bf16_f32 v48, v24, v25
    v_cvt_pk_bf16_f32 v49, v26, v27
    v_exp_f32 v32, v32
    v_exp_f32 v33, v33
    v_mfma_f32_32x32x16_bf16 v[56:71], v[132:135], v[44:47], v[56:71]
    v_cvt_pk_bf16_f32 v50, v28, v29
    v_cvt_pk_bf16_f32 v51, v30, v31
    v_exp_f32 v34, v34
    v_exp_f32 v35, v35
    v_exp_f32 v36, v36
    v_exp_f32 v37, v37
    v_cvt_pk_bf16_f32 v52, v32, v33
    v_exp_f32 v38, v38
    v_exp_f32 v39, v39
    v_cvt_pk_bf16_f32 v53, v34, v35
    v_cvt_pk_bf16_f32 v54, v36, v37
    v_cvt_pk_bf16_f32 v55, v38, v39
    v_mfma_f32_32x32x16_bf16 v[24:39], v[124:127], v[148:151], v[104:119]
    ds_read_b128 v[120:123], v2 offset:2048
    v_exp_f32 v8, v8
    v_exp_f32 v9, v9
    v_exp_f32 v10, v10
    v_exp_f32 v11, v11
    v_exp_f32 v12, v12
    v_mfma_f32_32x32x16_bf16 v[72:87], v[128:131], v[48:51], v[72:87]
    s_mov_b64 exec, s[24:25]
    ds_read_b128 v[136:139], v3 offset:1024
    ds_read_b128 v[140:143], v3 offset:1536
    s_mov_b64 exec, -1
    v_exp_f32 v13, v13
    v_exp_f32 v14, v14
    v_exp_f32 v15, v15
    v_cvt_pk_bf16_f32 v40, v8, v9
    v_cvt_pk_bf16_f32 v41, v10, v11
    v_exp_f32 v16, v16
    v_exp_f32 v17, v17
    v_mfma_f32_32x32x16_bf16 v[72:87], v[132:135], v[52:55], v[72:87]
    v_cvt_pk_bf16_f32 v42, v12, v13
    v_cvt_pk_bf16_f32 v43, v14, v15
    v_exp_f32 v18, v18
    v_exp_f32 v19, v19
    v_exp_f32 v20, v20
    v_exp_f32 v21, v21
    v_cvt_pk_bf16_f32 v44, v16, v17
    v_exp_f32 v22, v22
    v_exp_f32 v23, v23
    v_cvt_pk_bf16_f32 v45, v18, v19
    v_cvt_pk_bf16_f32 v46, v20, v21
    v_cvt_pk_bf16_f32 v47, v22, v23
    s_waitcnt lgkmcnt(0)
    v_mfma_f32_32x32x16_bf16 v[8:23], v[120:123], v[144:147], v[88:103]
    v_exp_f32 v24, v24
    v_exp_f32 v25, v25
    v_exp_f32 v26, v26
    v_exp_f32 v27, v27
    v_exp_f32 v28, v28
    v_mfma_f32_32x32x16_bf16 v[56:71], v[136:139], v[40:43], v[56:71]
    v_exp_f32 v29, v29
    v_exp_f32 v30, v30
    v_exp_f32 v31, v31
    v_cvt_pk_bf16_f32 v48, v24, v25
    v_cvt_pk_bf16_f32 v49, v26, v27
    v_exp_f32 v32, v32
    v_exp_f32 v33, v33
    v_mfma_f32_32x32x16_bf16 v[56:71], v[140:143], v[44:47], v[56:71]
    v_cvt_pk_bf16_f32 v50, v28, v29
    v_cvt_pk_bf16_f32 v51, v30, v31
    v_exp_f32 v34, v34
    v_exp_f32 v35, v35
    v_exp_f32 v36, v36
    v_exp_f32 v37, v37
    v_cvt_pk_bf16_f32 v52, v32, v33
    v_exp_f32 v38, v38
    v_exp_f32 v39, v39
    v_cvt_pk_bf16_f32 v53, v34, v35
    v_cvt_pk_bf16_f32 v54, v36, v37
    v_cvt_pk_bf16_f32 v55, v38, v39
    v_mfma_f32_32x32x16_bf16 v[24:39], v[120:123], v[148:151], v[104:119]
    ds_read_b128 v[124:127], v2 offset:3072
    v_exp_f32 v8, v8
    v_exp_f32 v9, v9
    v_exp_f32 v10, v10
    v_exp_f32 v11, v11
    v_exp_f32 v12, v12
    v_mfma_f32_32x32x16_bf16 v[72:87], v[136:139], v[48:51], v[72:87]
    s_mov_b64 exec, s[24:25]
    ds_read_b128 v[128:131], v3 offset:2048
    ds_read_b128 v[132:135], v3 offset:2560
    s_mov_b64 exec, -1
    v_exp_f32 v13, v13
    v_exp_f32 v14, v14
    v_exp_f32 v15, v15
    v_cvt_pk_bf16_f32 v40, v8, v9
    v_cvt_pk_bf16_f32 v41, v10, v11
    v_exp_f32 v16, v16
    v_exp_f32 v17, v17
    v_mfma_f32_32x32x16_bf16 v[72:87], v[140:143], v[52:55], v[72:87]
    v_cvt_pk_bf16_f32 v42, v12, v13
    v_cvt_pk_bf16_f32 v43, v14, v15
    v_exp_f32 v18, v18
    v_exp_f32 v19, v19
    v_exp_f32 v20, v20
    v_exp_f32 v21, v21
    v_cvt_pk_bf16_f32 v44, v16, v17
    v_exp_f32 v22, v22
    v_exp_f32 v23, v23
    v_cvt_pk_bf16_f32 v45, v18, v19
    v_cvt_pk_bf16_f32 v46, v20, v21
    v_cvt_pk_bf16_f32 v47, v22, v23
    s_waitcnt lgkmcnt(0)
    v_mfma_f32_32x32x16_bf16 v[8:23], v[124:127], v[144:147], v[88:103]
    v_exp_f32 v24, v24
    v_exp_f32 v25, v25
    v_exp_f32 v26, v26
    v_exp_f32 v27, v27
    v_exp_f32 v28, v28
    v_mfma_f32_32x32x16_bf16 v[56:71], v[128:131], v[40:43], v[56:71]
    v_exp_f32 v29, v29
    v_exp_f32 v30, v30
    v_exp_f32 v31, v31
    v_cvt_pk_bf16_f32 v48, v24, v25
    v_cvt_pk_bf16_f32 v49, v26, v27
    v_exp_f32 v32, v32
    v_exp_f32 v33, v33
    v_mfma_f32_32x32x16_bf16 v[56:71], v[132:135], v[44:47], v[56:71]
    v_cvt_pk_bf16_f32 v50, v28, v29
    v_cvt_pk_bf16_f32 v51, v30, v31
    v_exp_f32 v34, v34
    v_exp_f32 v35, v35
    v_exp_f32 v36, v36
    v_exp_f32 v37, v37
    v_cvt_pk_bf16_f32 v52, v32, v33
    v_exp_f32 v38, v38
    v_exp_f32 v39, v39
    v_cvt_pk_bf16_f32 v53, v34, v35
    v_cvt_pk_bf16_f32 v54, v36, v37
    v_cvt_pk_bf16_f32 v55, v38, v39
    v_mfma_f32_32x32x16_bf16 v[24:39], v[124:127], v[148:151], v[104:119]
    ds_read_b128 v[120:123], v2 offset:4096
    v_exp_f32 v8, v8
    v_exp_f32 v9, v9
    v_exp_f32 v10, v10
    v_exp_f32 v11, v11
    v_exp_f32 v12, v12
    v_mfma_f32_32x32x16_bf16 v[72:87], v[128:131], v[48:51], v[72:87]
    s_mov_b64 exec, s[24:25]
    ds_read_b128 v[136:139], v3 offset:3072
    ds_read_b128 v[140:143], v3 offset:3584
    s_mov_b64 exec, -1
    v_exp_f32 v13, v13
    v_exp_f32 v14, v14
    v_exp_f32 v15, v15
    v_cvt_pk_bf16_f32 v40, v8, v9
    v_cvt_pk_bf16_f32 v41, v10, v11
    v_exp_f32 v16, v16
    v_exp_f32 v17, v17
    v_mfma_f32_32x32x16_bf16 v[72:87], v[132:135], v[52:55], v[72:87]
    v_cvt_pk_bf16_f32 v42, v12, v13
    v_cvt_pk_bf16_f32 v43, v14, v15
    v_exp_f32 v18, v18
    v_exp_f32 v19, v19
    v_exp_f32 v20, v20
    v_exp_f32 v21, v21
    v_cvt_pk_bf16_f32 v44, v16, v17
    v_exp_f32 v22, v22
    v_exp_f32 v23, v23
    v_cvt_pk_bf16_f32 v45, v18, v19
    v_cvt_pk_bf16_f32 v46, v20, v21
    v_cvt_pk_bf16_f32 v47, v22, v23
    s_waitcnt lgkmcnt(0)
    v_mfma_f32_32x32x16_bf16 v[8:23], v[120:123], v[144:147], v[88:103]
    v_exp_f32 v24, v24
    v_exp_f32 v25, v25
    v_exp_f32 v26, v26
    v_exp_f32 v27, v27
    v_exp_f32 v28, v28
    v_mfma_f32_32x32x16_bf16 v[56:71], v[136:139], v[40:43], v[56:71]
    v_exp_f32 v29, v29
    v_exp_f32 v30, v30
    v_exp_f32 v31, v31
    v_cvt_pk_bf16_f32 v48, v24, v25
    v_cvt_pk_bf16_f32 v49, v26, v27
    v_exp_f32 v32, v32
    v_exp_f32 v33, v33
    v_mfma_f32_32x32x16_bf16 v[56:71], v[140:143], v[44:47], v[56:71]
    v_cvt_pk_bf16_f32 v50, v28, v29
    v_cvt_pk_bf16_f32 v51, v30, v31
    v_exp_f32 v34, v34
    v_exp_f32 v35, v35
    v_exp_f32 v36, v36
    v_exp_f32 v37, v37
    v_cvt_pk_bf16_f32 v52, v32, v33
    v_exp_f32 v38, v38
    v_exp_f32 v39, v39
    v_cvt_pk_bf16_f32 v53, v34, v35
    v_cvt_pk_bf16_f32 v54, v36, v37
    v_cvt_pk_bf16_f32 v55, v38, v39
    v_mfma_f32_32x32x16_bf16 v[24:39], v[120:123], v[148:151], v[104:119]
    ds_read_b128 v[124:127], v2 offset:5120
    v_exp_f32 v8, v8
    v_exp_f32 v9, v9
    v_exp_f32 v10, v10
    v_exp_f32 v11, v11
    v_exp_f32 v12, v12
    v_mfma_f32_32x32x16_bf16 v[72:87], v[136:139], v[48:51], v[72:87]
    s_mov_b64 exec, s[24:25]
    ds_read_b128 v[128:131], v3 offset:4096
    ds_read_b128 v[132:135], v3 offset:4608
    s_mov_b64 exec, -1
    v_exp_f32 v13, v13
    v_exp_f32 v14, v14
    v_exp_f32 v15, v15
    v_cvt_pk_bf16_f32 v40, v8, v9
    v_cvt_pk_bf16_f32 v41, v10, v11
    v_exp_f32 v16, v16
    v_exp_f32 v17, v17
    v_mfma_f32_32x32x16_bf16 v[72:87], v[140:143], v[52:55], v[72:87]
    v_cvt_pk_bf16_f32 v42, v12, v13
    v_cvt_pk_bf16_f32 v43, v14, v15
    v_exp_f32 v18, v18
    v_exp_f32 v19, v19
    v_exp_f32 v20, v20
    v_exp_f32 v21, v21
    v_cvt_pk_bf16_f32 v44, v16, v17
    v_exp_f32 v22, v22
    v_exp_f32 v23, v23
    v_cvt_pk_bf16_f32 v45, v18, v19
    v_cvt_pk_bf16_f32 v46, v20, v21
    v_cvt_pk_bf16_f32 v47, v22, v23
    s_waitcnt lgkmcnt(0)
    v_mfma_f32_32x32x16_bf16 v[8:23], v[124:127], v[144:147], v[88:103]
    v_exp_f32 v24, v24
    v_exp_f32 v25, v25
    v_exp_f32 v26, v26
    v_exp_f32 v27, v27
    v_exp_f32 v28, v28
    v_mfma_f32_32x32x16_bf16 v[56:71], v[128:131], v[40:43], v[56:71]
    v_exp_f32 v29, v29
    v_exp_f32 v30, v30
    v_exp_f32 v31, v31
    v_cvt_pk_bf16_f32 v48, v24, v25
    v_cvt_pk_bf16_f32 v49, v26, v27
    v_exp_f32 v32, v32
    v_exp_f32 v33, v33
    v_mfma_f32_32x32x16_bf16 v[56:71], v[132:135], v[44:47], v[56:71]
    v_cvt_pk_bf16_f32 v50, v28, v29
    v_cvt_pk_bf16_f32 v51, v30, v31
    v_exp_f32 v34, v34
    v_exp_f32 v35, v35
    v_exp_f32 v36, v36
    v_exp_f32 v37, v37
    v_cvt_pk_bf16_f32 v52, v32, v33
    v_exp_f32 v38, v38
    v_exp_f32 v39, v39
    v_cvt_pk_bf16_f32 v53, v34, v35
    v_cvt_pk_bf16_f32 v54, v36, v37
    v_cvt_pk_bf16_f32 v55, v38, v39
    v_mfma_f32_32x32x16_bf16 v[24:39], v[124:127], v[148:151], v[104:119]
    ds_read_b128 v[120:123], v2 offset:6144
    v_exp_f32 v8, v8
    v_exp_f32 v9, v9
    v_exp_f32 v10, v10
    v_exp_f32 v11, v11
    v_exp_f32 v12, v12
    v_mfma_f32_32x32x16_bf16 v[72:87], v[128:131], v[48:51], v[72:87]
    s_mov_b64 exec, s[24:25]
    ds_read_b128 v[136:139], v3 offset:5120
    ds_read_b128 v[140:143], v3 offset:5632
    s_mov_b64 exec, -1
    v_exp_f32 v13, v13
    v_exp_f32 v14, v14
    v_exp_f32 v15, v15
    v_cvt_pk_bf16_f32 v40, v8, v9
    v_cvt_pk_bf16_f32 v41, v10, v11
    v_exp_f32 v16, v16
    v_exp_f32 v17, v17
    v_mfma_f32_32x32x16_bf16 v[72:87], v[132:135], v[52:55], v[72:87]
    v_cvt_pk_bf16_f32 v42, v12, v13
    v_cvt_pk_bf16_f32 v43, v14, v15
    v_exp_f32 v18, v18
    v_exp_f32 v19, v19
    v_exp_f32 v20, v20
    v_exp_f32 v21, v21
    v_cvt_pk_bf16_f32 v44, v16, v17
    v_exp_f32 v22, v22
    v_exp_f32 v23, v23
    v_cvt_pk_bf16_f32 v45, v18, v19
    v_cvt_pk_bf16_f32 v46, v20, v21
    v_cvt_pk_bf16_f32 v47, v22, v23
    s_waitcnt lgkmcnt(0)
    v_mfma_f32_32x32x16_bf16 v[8:23], v[120:123], v[144:147], v[88:103]
    v_exp_f32 v24, v24
    v_exp_f32 v25, v25
    v_exp_f32 v26, v26
    v_exp_f32 v27, v27
    v_exp_f32 v28, v28
    v_mfma_f32_32x32x16_bf16 v[56:71], v[136:139], v[40:43], v[56:71]
    v_exp_f32 v29, v29
    v_exp_f32 v30, v30
    v_exp_f32 v31, v31
    v_cvt_pk_bf16_f32 v48, v24, v25
    v_cvt_pk_bf16_f32 v49, v26, v27
    v_exp_f32 v32, v32
    v_exp_f32 v33, v33
    v_mfma_f32_32x32x16_bf16 v[56:71], v[140:143], v[44:47], v[56:71]
    v_cvt_pk_bf16_f32 v50, v28, v29
    v_cvt_pk_bf16_f32 v51, v30, v31
    v_exp_f32 v34, v34
    v_exp_f32 v35, v35
    v_exp_f32 v36, v36
    v_exp_f32 v37, v37
    v_cvt_pk_bf16_f32 v52, v32, v33
    v_exp_f32 v38, v38
    v_exp_f32 v39, v39
    v_cvt_pk_bf16_f32 v53, v34, v35
    v_cvt_pk_bf16_f32 v54, v36, v37
    v_cvt_pk_bf16_f32 v55, v38, v39
    v_mfma_f32_32x32x16_bf16 v[24:39], v[120:123], v[148:151], v[104:119]
    ds_read_b128 v[124:127], v2 offset:7168
    v_exp_f32 v8, v8
    v_exp_f32 v9, v9
    v_exp_f32 v10, v10
    v_exp_f32 v11, v11
    v_exp_f32 v12, v12
    v_mfma_f32_32x32x16_bf16 v[72:87], v[136:139], v[48:51], v[72:87]
    s_mov_b64 exec, s[24:25]
    ds_read_b128 v[128:131], v3 offset:6144
    ds_read_b128 v[132:135], v3 offset:6656
    s_mov_b64 exec, -1
    v_exp_f32 v13, v13
    v_exp_f32 v14, v14
    v_exp_f32 v15, v15
    v_cvt_pk_bf16_f32 v40, v8, v9
    v_cvt_pk_bf16_f32 v41, v10, v11
    v_exp_f32 v16, v16
    v_exp_f32 v17, v17
    v_mfma_f32_32x32x16_bf16 v[72:87], v[140:143], v[52:55], v[72:87]
    v_cvt_pk_bf16_f32 v42, v12, v13
    v_cvt_pk_bf16_f32 v43, v14, v15
    v_exp_f32 v18, v18
    v_exp_f32 v19, v19
    v_exp_f32 v20, v20
    v_exp_f32 v21, v21
    v_cvt_pk_bf16_f32 v44, v16, v17
    v_exp_f32 v22, v22
    v_exp_f32 v23, v23
    v_cvt_pk_bf16_f32 v45, v18, v19
    v_cvt_pk_bf16_f32 v46, v20, v21
    v_cvt_pk_bf16_f32 v47, v22, v23
    s_waitcnt lgkmcnt(0)
    v_mfma_f32_32x32x16_bf16 v[8:23], v[124:127], v[144:147], v[88:103]
    v_exp_f32 v24, v24
    v_exp_f32 v25, v25
    v_exp_f32 v26, v26
    v_exp_f32 v27, v27
    v_exp_f32 v28, v28
    v_mfma_f32_32x32x16_bf16 v[56:71], v[128:131], v[40:43], v[56:71]
    v_exp_f32 v29, v29
    v_exp_f32 v30, v30
    v_exp_f32 v31, v31
    v_cvt_pk_bf16_f32 v48, v24, v25
    v_cvt_pk_bf16_f32 v49, v26, v27
    v_exp_f32 v32, v32
    v_exp_f32 v33, v33
    v_mfma_f32_32x32x16_bf16 v[56:71], v[132:135], v[44:47], v[56:71]
    v_cvt_pk_bf16_f32 v50, v28, v29
    v_cvt_pk_bf16_f32 v51, v30, v31
    v_exp_f32 v34, v34
    v_exp_f32 v35, v35
    v_exp_f32 v36, v36
    v_exp_f32 v37, v37
    v_cvt_pk_bf16_f32 v52, v32, v33
    v_exp_f32 v38, v38
    v_exp_f32 v39, v39
    v_cvt_pk_bf16_f32 v53, v34, v35
    v_cvt_pk_bf16_f32 v54, v36, v37
    v_cvt_pk_bf16_f32 v55, v38, v39
    s_cmp_eq_u32 s26, s28
    s_cbranch_scc1 L_kf_doB
L_kf_retB:
    v_mfma_f32_32x32x16_bf16 v[24:39], v[124:127], v[148:151], v[104:119]
    ds_read_b128 v[120:123], v2 offset:8192
    v_exp_f32 v8, v8
    v_exp_f32 v9, v9
    v_exp_f32 v10, v10
    v_exp_f32 v11, v11
    v_exp_f32 v12, v12
    v_mfma_f32_32x32x16_bf16 v[72:87], v[128:131], v[48:51], v[72:87]
    s_mov_b64 exec, s[24:25]
    ds_read_b128 v[136:139], v3 offset:7168
    ds_read_b128 v[140:143], v3 offset:7680
    s_mov_b64 exec, -1
    v_exp_f32 v13, v13
    v_exp_f32 v14, v14
    v_exp_f32 v15, v15
    v_cvt_pk_bf16_f32 v40, v8, v9
    v_cvt_pk_bf16_f32 v41, v10, v11
    v_exp_f32 v16, v16
    v_exp_f32 v17, v17
    v_mfma_f32_32x32x16_bf16 v[72:87], v[132:135], v[52:55], v[72:87]
    v_cvt_pk_bf16_f32 v42, v12, v13
    v_cvt_pk_bf16_f32 v43, v14, v15
    v_exp_f32 v18, v18
    v_exp_f32 v19, v19
    v_exp_f32 v20, v20
    v_exp_f32 v21, v21
    v_cvt_pk_bf16_f32 v44, v16, v17
    v_exp_f32 v22, v22
    v_exp_f32 v23, v23
    v_cvt_pk_bf16_f32 v45, v18, v19
    v_cvt_pk_bf16_f32 v46, v20, v21
    v_cvt_pk_bf16_f32 v47, v22, v23
    s_waitcnt lgkmcnt(0)
    v_mfma_f32_32x32x16_bf16 v[8:23], v[120:123], v[144:147], v[88:103]
    v_exp_f32 v24, v24
    v_exp_f32 v25, v25
    v_exp_f32 v26, v26
    v_exp_f32 v27, v27
    v_exp_f32 v28, v28
    v_mfma_f32_32x32x16_bf16 v[56:71], v[136:139], v[40:43], v[56:71]
    v_exp_f32 v29, v29
    v_exp_f32 v30, v30
    v_exp_f32 v31, v31
    v_cvt_pk_bf16_f32 v48, v24, v25
    v_cvt_pk_bf16_f32 v49, v26, v27
    v_exp_f32 v32, v32
    v_exp_f32 v33, v33
    v_mfma_f32_32x32x16_bf16 v[56:71], v[140:143], v[44:47], v[56:71]
    v_cvt_pk_bf16_f32 v50, v28, v29
    v_cvt_pk_bf16_f32 v51, v30, v31
    v_exp_f32 v34, v34
    v_exp_f32 v35, v35
    v_exp_f32 v36, v36
    v_exp_f32 v37, v37
    v_cvt_pk_bf16_f32 v52, v32, v33
    v_exp_f32 v38, v38
    v_exp_f32 v39, v39
    v_cvt_pk_bf16_f32 v53, v34, v35
    v_cvt_pk_bf16_f32 v54, v36, v37
    v_cvt_pk_bf16_f32 v55, v38, v39
    v_add_u32 v2, 8192, v2
    v_add_u32 v3, 8192, v3
    s_add_u32 s26, s26, 1
    s_cmp_lg_u32 s26, 8
    s_cbranch_scc1 L_kf_loop
    v_mfma_f32_32x32x16_bf16 v[72:87], v[136:139], v[48:51], v[72:87]
    v_mfma_f32_32x32x16_bf16 v[72:87], v[140:143], v[52:55], v[72:87]
    s_lshl_b32 s19, s18, 3
    s_lshl_b32 s21, s34, 1
    s_add_u32 s19, s19, s21
    s_lshl_b32 s19, s19, 5
    s_add_u32 s19, s19, s17
    s_lshl_b32 s19, s19, 10
    s_add_u32 s19, s19, 0x1400000
    s_add_u32 s21, s19, 32768
    v_rcp_f32 v152, v64
    s_nop 0
    v_mul_f32 v56, v56, v152
    v_mul_f32 v57, v57, v152
    v_mul_f32 v58, v58, v152
    v_mul_f32 v59, v59, v152
    v_mul_f32 v60, v60, v152
    v_mul_f32 v61, v61, v152
    v_mul_f32 v62, v62, v152
    v_mul_f32 v63, v63, v152
    v_cvt_pk_bf16_f32 v156, v56, v57
    v_cvt_pk_bf16_f32 v157, v58, v59
    v_cvt_pk_bf16_f32 v158, v60, v61
    v_cvt_pk_bf16_f32 v159, v62, v63
    buffer_store_dwordx4 v[156:159], v4, s[8:11], s19 offen sc1
    s_nop 3
    v_rcp_f32 v152, v80
    s_nop 0
    v_mul_f32 v72, v72, v152
    v_mul_f32 v73, v73, v152
    v_mul_f32 v74, v74, v152
    v_mul_f32 v75, v75, v152
    v_mul_f32 v76, v76, v152
    v_mul_f32 v77, v77, v152
    v_mul_f32 v78, v78, v152
    v_mul_f32 v79, v79, v152
    v_cvt_pk_bf16_f32 v160, v72, v73
    v_cvt_pk_bf16_f32 v161, v74, v75
    v_cvt_pk_bf16_f32 v162, v76, v77
    v_cvt_pk_bf16_f32 v163, v78, v79
    buffer_store_dwordx4 v[160:163], v4, s[8:11], s21 offen sc1
    s_lshl_b32 s20, s18, 2
    s_add_u32 s20, s20, s34
    s_lshl_b32 s20, s20, 7
    s_add_u32 s20, s20, 0x1d01000
    s_waitcnt vmcnt(0)
    v_mov_b32 v152, 0
    v_mov_b32 v153, 1
    s_mov_b64 exec, 1
    buffer_atomic_add v153, v152, s[8:11], s20 offen sc1
    s_mov_b64 exec, -1
    s_barrier
    s_add_u32 s40, s40, 4
    s_branch L_k1_end
L_kf_doB:
    s_waitcnt vmcnt(0)
    s_barrier
    s_cmp_ge_u32 s66, 72
    s_cbranch_scc1 L_norsig_32
    s_cmp_lg_u32 s34, 0
    s_cbranch_scc1 L_norsig_32
    s_and_b32 s20, s66, 7
    s_lshl_b32 s20, s20, 7
    s_add_u32 s20, s20, 0x1d00c00
    v_mov_b32 v154, 0
    v_mov_b32 v155, 1
    s_mov_b64 exec, 1
    buffer_atomic_add v155, v154, s[8:11], s20 offen sc1
    s_mov_b64 exec, -1
L_norsig_32:
    s_branch L_kf_retB
L_k1_end:
L_k1_exit:
    s_endpgm
.section .rodata,"a"
.p2align 6
.amdhsa_kernel parallel_sum__softmax_full_mha__glu_gated_bilinear__prompt_kernel
  .amdhsa_next_free_vgpr 256
  .amdhsa_next_free_sgpr 102
  .amdhsa_accum_offset 256
  .amdhsa_group_segment_fixed_size 0
  .amdhsa_kernarg_size 80
  .amdhsa_user_sgpr_count 2
  .amdhsa_user_sgpr_kernarg_segment_ptr 1
  .amdhsa_system_sgpr_workgroup_id_x 1
  .amdhsa_float_denorm_mode_32 3
  .amdhsa_float_denorm_mode_16_64 3
.end_amdhsa_kernel
```
